```python
import torch

def _softmax(x, axis=-1):
    return torch.softmax(x, dim=axis)
def _gelu(x):
    return torch.nn.functional.gelu(x, approximate="tanh")
def _silu(x):
    return torch.nn.functional.silu(x)
def _sigmoid(x):
    return torch.sigmoid(x)
def _layernorm(x, axis=-1, eps=1e-5):
    m = x.mean(dim=axis, keepdim=True)
    v = x.var(dim=axis, keepdim=True, unbiased=False)
    return (x - m) / torch.sqrt(v + eps)
def _scatter_add(tgt, idx, src, axis=0):
    return tgt.clone().index_add_(axis, idx, src)
def _segment_sum(src, seg, n):
    out = torch.zeros((n,) + src.shape[1:], dtype=src.dtype)
    return out.index_add_(0, seg, src)
def _pad(x, pw):
    flat = tuple(v for pair in reversed(pw) for v in pair)
    return torch.nn.functional.pad(x, flat)

kernel_name = 'standalone__dense_activation_squared_relu__prompt'

def setup_inputs():

    _w = (lambda a: (lambda t: t.to(torch.bfloat16) if t.is_floating_point() else t)(torch.as_tensor(a)))
    B, S, D, F = 1, 2048, 1024, 3584
    return {
        "x": _w((lambda *s: torch.randn(*s, dtype=torch.bfloat16) * 0.05)(B, S, D)),
        "w1": _w((lambda *s: torch.randn(*s, dtype=torch.bfloat16) * 0.05)(D, F)),
        "b1": _w((lambda *s: torch.randn(*s, dtype=torch.bfloat16) * 0.05)(F)),
        "w2": _w((lambda *s: torch.randn(*s, dtype=torch.bfloat16) * 0.05)(F, D)),
        "b2": _w((lambda *s: torch.randn(*s, dtype=torch.bfloat16) * 0.05)(D)),
    }

def reference(x, w1, b1, w2, b2):
    h = torch.einsum("bsd,df->bsf", x, w1) + b1
    zero = torch.zeros_like(h)
    r = torch.where(h > zero, h, zero)
    h = r * r
    out = torch.einsum("bsf,fd->bsd", h, w2) + b2
    return out
```

```asm
; @launch grid=(256,1,1) block=(512,1,1) lds=141312
.amdgcn_target "amdgcn-amd-amdhsa--gfx950"
.text
.globl standalone__dense_activation_squared_relu__prompt_kernel
.p2align 8
.type standalone__dense_activation_squared_relu__prompt_kernel,@function
standalone__dense_activation_squared_relu__prompt_kernel:
    s_cmp_ge_u32 s2, 256
    s_cbranch_scc1 L1_end
    s_load_dwordx4 s[4:7], s[0:1], 0
    s_load_dwordx4 s[8:11], s[0:1], 16
    s_load_dwordx4 s[88:91], s[0:1], 32
    s_load_dwordx4 s[44:47], s[0:1], 48
    v_lshrrev_b32 v1, 6, v0
    v_and_b32 v0, 63, v0
    s_lshr_b32 s13, s2, 3
    v_readfirstlane_b32 s3, v1
    v_lshrrev_b32 v3, 4, v0
    s_and_b32 s18, s13, 3
    s_lshr_b32 s19, s13, 2
    s_and_b32 s12, s2, 3
    s_lshl_b32 s12, s12, 2
    s_add_u32 s12, s12, s18
    s_and_b32 s13, s2, 4
    s_lshr_b32 s14, s13, 2
    s_lshl_b32 s13, s13, 1
    s_add_u32 s13, s13, s19
    s_cmp_lt_u32 s3, 4
    s_cbranch_scc1 L_main
    s_sub_u32 s3, s3, 4
    v_lshrrev_b32 v2, 3, v0
    v_and_b32 v4, 7, v0
    v_xor_b32 v4, v4, v3
    s_lshl_b32 s16, s3, 16
    v_lshlrev_b32 v2, 11, v2
    v_add_u32 v2, s16, v2
    v_lshl_add_u32 v24, v4, 4, v2
    v_xor_b32 v4, 4, v4
    v_lshl_add_u32 v25, v4, 4, v2
    v_add_u32 v26, 30720, v24
    v_add_u32 v27, 46080, v25
    v_add_u32 v25, 15360, v25
    s_mul_i32 s36, s3, 7168
    s_lshl_b32 s43, s3, 12
    s_mov_b32 s15, 9363
    s_mul_i32 s40, s3, 16*7168
    s_lshl_b32 s16, s12, 18
    s_mul_i32 s41, s13, 448
    s_mul_i32 s60, s18, 1
    s_mul_i32 s61, s19, 1
    s_add_u32 s60, s60, s61
    s_and_b32 s60, s60, 3
    s_mov_b32 s61, 0
    s_mov_b32 s62, 0
    s_mul_i32 s37, s60, 458752
    s_lshl_b32 s38, s60, 7
    s_waitcnt lgkmcnt(0)
    s_add_u32 s20, s4, s16
    s_addc_u32 s21, s5, 0
    s_and_b32 s21, s21, 0xffff
    s_mov_b32 s22, 262144
    s_mov_b32 s23, 0x20000
    s_add_u32 m0, s43, 57344
    s_nop 0
    buffer_load_dwordx4 v24, s[20:23], s38 offen offset:0 lds
    buffer_load_dwordx4 v25, s[20:23], s38 offen offset:1024 lds
    buffer_load_dwordx4 v26, s[20:23], s38 offen offset:2048 lds
    buffer_load_dwordx4 v27, s[20:23], s38 offen offset:3072 lds
    s_add_u32 s24, s6, s41
    s_addc_u32 s25, s7, 0
    s_and_b32 s25, s25, 0xffff
    s_sub_u32 s26, 7340032, s41
    s_mov_b32 s27, 0x20000
    v_add_u32 v2, 0, v0
    v_mul_u32_u24 v7, s15, v2
    v_lshrrev_b32 v7, 18, v7
    v_mul_u32_u24 v4, 28, v7
    v_sub_u32 v4, v2, v4
    v_lshrrev_b32 v5, 2, v7
    v_and_b32 v5, 2, v5
    v_xor_b32 v4, v4, v5
    v_mul_u32_u24 v7, 7168, v7
    v_lshl_add_u32 v7, v4, 4, v7
    v_add_u32 v7, s40, v7
    v_subrev_u32 v16, 0, v7
    s_add_u32 m0, s36, 0
    s_nop 0
    buffer_load_dwordx4 v16, s[24:27], s37 offen offset:0 lds
    v_add_u32 v2, 64, v0
    v_mul_u32_u24 v7, s15, v2
    v_lshrrev_b32 v7, 18, v7
    v_mul_u32_u24 v4, 28, v7
    v_sub_u32 v4, v2, v4
    v_lshrrev_b32 v5, 2, v7
    v_and_b32 v5, 2, v5
    v_xor_b32 v4, v4, v5
    v_mul_u32_u24 v7, 7168, v7
    v_lshl_add_u32 v7, v4, 4, v7
    v_add_u32 v7, s40, v7
    v_subrev_u32 v17, 1024, v7
    buffer_load_dwordx4 v17, s[24:27], s37 offen offset:1024 lds
    v_add_u32 v2, 128, v0
    v_mul_u32_u24 v7, s15, v2
    v_lshrrev_b32 v7, 18, v7
    v_mul_u32_u24 v4, 28, v7
    v_sub_u32 v4, v2, v4
    v_lshrrev_b32 v5, 2, v7
    v_and_b32 v5, 2, v5
    v_xor_b32 v4, v4, v5
    v_mul_u32_u24 v7, 7168, v7
    v_lshl_add_u32 v7, v4, 4, v7
    v_add_u32 v7, s40, v7
    v_subrev_u32 v18, 2048, v7
    buffer_load_dwordx4 v18, s[24:27], s37 offen offset:2048 lds
    s_lshl_b32 s42, s2, 2
    s_add_u32 s42, s42, s3
    s_lshl_b32 s16, s42, 12
    s_add_u32 s28, s4, s16
    s_addc_u32 s29, s5, 0
    s_mul_i32 s16, s42, 896
    s_add_u32 s16, s16, 7340032
    s_add_u32 s30, s6, s16
    s_addc_u32 s31, s7, 0
    v_add_u32 v2, 192, v0
    v_mul_u32_u24 v7, s15, v2
    v_lshrrev_b32 v7, 18, v7
    v_mul_u32_u24 v4, 28, v7
    v_sub_u32 v4, v2, v4
    v_lshrrev_b32 v5, 2, v7
    v_and_b32 v5, 2, v5
    v_xor_b32 v4, v4, v5
    v_mul_u32_u24 v7, 7168, v7
    v_lshl_add_u32 v7, v4, 4, v7
    v_add_u32 v7, s40, v7
    v_subrev_u32 v19, 3072, v7
    buffer_load_dwordx4 v19, s[24:27], s37 offen offset:3072 lds
    v_add_u32 v2, 256, v0
    v_mul_u32_u24 v7, s15, v2
    v_lshrrev_b32 v7, 18, v7
    v_mul_u32_u24 v4, 28, v7
    v_sub_u32 v4, v2, v4
    v_lshrrev_b32 v5, 2, v7
    v_and_b32 v5, 2, v5
    v_xor_b32 v4, v4, v5
    v_mul_u32_u24 v7, 7168, v7
    v_lshl_add_u32 v7, v4, 4, v7
    v_add_u32 v7, s40, v7
    v_subrev_u32 v20, 0, v7
    s_add_u32 m0, s36, 4096
    s_nop 0
    buffer_load_dwordx4 v20, s[24:27], s37 offen offset:0 lds
    v_add_u32 v2, 320, v0
    v_mul_u32_u24 v7, s15, v2
    v_lshrrev_b32 v7, 18, v7
    v_mul_u32_u24 v4, 28, v7
    v_sub_u32 v4, v2, v4
    v_lshrrev_b32 v5, 2, v7
    v_and_b32 v5, 2, v5
    v_xor_b32 v4, v4, v5
    v_mul_u32_u24 v7, 7168, v7
    v_lshl_add_u32 v7, v4, 4, v7
    v_add_u32 v7, s40, v7
    v_subrev_u32 v21, 1024, v7
    buffer_load_dwordx4 v21, s[24:27], s37 offen offset:1024 lds
    v_add_u32 v2, 384, v0
    v_mul_u32_u24 v7, s15, v2
    v_lshrrev_b32 v7, 18, v7
    v_mul_u32_u24 v4, 28, v7
    v_sub_u32 v4, v2, v4
    v_lshrrev_b32 v5, 2, v7
    v_and_b32 v5, 2, v5
    v_xor_b32 v4, v4, v5
    v_mul_u32_u24 v7, 7168, v7
    v_lshl_add_u32 v7, v4, 4, v7
    v_add_u32 v7, s40, v7
    v_subrev_u32 v22, 2048, v7
    buffer_load_dwordx4 v22, s[24:27], s37 offen offset:2048 lds
    s_mov_b32 s48, s4
    s_and_b32 s49, s5, 0xffff
    s_mov_b32 s50, 4194304
    s_mov_b32 s51, 0x20000
    s_mov_b32 s56, s6
    s_and_b32 s57, s7, 0xffff
    s_mov_b32 s58, 7340032
    s_mov_b32 s59, 0x20000
    s_add_u32 s60, s60, 1
    s_cmp_eq_u32 s60, 4
    s_cselect_b32 s60, 0, s60
    s_add_u32 s61, s61, 1
    s_cmp_eq_u32 s61, 4
    s_cselect_b32 s16, 4, 0
    s_cselect_b32 s61, 0, s61
    s_add_u32 s62, s62, s16
    s_add_u32 s16, s62, s60
    s_mul_i32 s37, s16, 458752
    s_lshl_b32 s38, s16, 7
    s_add_u32 m0, s43, 73728
    s_nop 0
    buffer_load_dwordx4 v24, s[20:23], s38 offen offset:0 lds
    buffer_load_dwordx4 v25, s[20:23], s38 offen offset:1024 lds
    buffer_load_dwordx4 v26, s[20:23], s38 offen offset:2048 lds
    buffer_load_dwordx4 v27, s[20:23], s38 offen offset:3072 lds
    s_add_u32 m0, s36, 28672
    s_nop 0
    buffer_load_dwordx4 v16, s[24:27], s37 offen offset:0 lds
    buffer_load_dwordx4 v17, s[24:27], s37 offen offset:1024 lds
    buffer_load_dwordx4 v18, s[24:27], s37 offen offset:2048 lds
    buffer_load_dwordx4 v19, s[24:27], s37 offen offset:3072 lds
    s_add_u32 m0, s36, 32768
    s_nop 0
    buffer_load_dwordx4 v20, s[24:27], s37 offen offset:0 lds
    buffer_load_dwordx4 v21, s[24:27], s37 offen offset:1024 lds
    buffer_load_dwordx4 v22, s[24:27], s37 offen offset:2048 lds
    s_add_u32 s60, s60, 1
    s_cmp_eq_u32 s60, 4
    s_cselect_b32 s60, 0, s60
    s_add_u32 s61, s61, 1
    s_cmp_eq_u32 s61, 4
    s_cselect_b32 s16, 4, 0
    s_cselect_b32 s61, 0, s61
    s_add_u32 s62, s62, s16
    s_add_u32 s16, s62, s60
    s_mul_i32 s37, s16, 458752
    s_lshl_b32 s38, s16, 7
    s_mov_b32 s52, s10
    s_and_b32 s53, s11, 0xffff
    s_mov_b32 s54, 7340032
    s_mov_b32 s55, 0x20000
    v_and_b32 v4, 15, v0
    v_lshlrev_b32 v5, 1, v3
    v_xor_b32 v4, v4, v5
    s_and_b32 s16, s3, 1
    s_lshl_b32 s16, s16, 15
    s_lshl_b32 s17, s19, 8
    s_add_u32 s16, s16, s17
    v_lshlrev_b32 v2, 11, v3
    v_add_u32 v2, s16, v2
    v_lshl_add_u32 v28, v4, 4, v2
    v_xor_b32 v4, 8, v4
    v_lshl_add_u32 v29, v4, 4, v2
    v_add_u32 v30, 14336, v28
    v_add_u32 v31, 21504, v29
    v_add_u32 v29, 7168, v29
    s_waitcnt vmcnt(11)
    s_barrier
    s_lshl_b32 s16, s12, 2
    s_add_u32 s16, s16, s3
    s_lshr_b32 s17, s16, 1
    s_lshl_b32 s17, s17, 11
    s_and_b32 s16, s16, 1
    s_lshl_b32 s16, s16, 7
    s_add_u32 s16, s16, s17
    s_lshl_b32 s17, s19, 8
    s_add_u32 s16, s16, s17
    s_add_u32 s32, s10, s16
    s_addc_u32 s33, s11, 0
    s_mul_i32 s94, s13, 7
    s_mul_i32 s95, s14, 56
    s_lshr_b32 s97, s3, 1
    s_add_u32 s96, s95, s97
    s_sub_u32 s96, s96, 1
    s_add_u32 s43, s43, 0
    s_lshl_b32 s86, s3, 12
    s_add_u32 s86, s86, 73728
    s_add_u32 m0, s43, 90112
    s_nop 0
    buffer_load_dwordx4 v24, s[20:23], s38 offen offset:0 lds
    buffer_load_dwordx4 v25, s[20:23], s38 offen offset:1024 lds
    buffer_load_dwordx4 v26, s[20:23], s38 offen offset:2048 lds
    buffer_load_dwordx4 v27, s[20:23], s38 offen offset:3072 lds
    s_add_u32 m0, s36, 106496
    s_nop 0
    buffer_load_dwordx4 v16, s[24:27], s37 offen offset:0 lds
    buffer_load_dwordx4 v17, s[24:27], s37 offen offset:1024 lds
    buffer_load_dwordx4 v18, s[24:27], s37 offen offset:2048 lds
    buffer_load_dwordx4 v19, s[24:27], s37 offen offset:3072 lds
    s_add_u32 m0, s36, 110592
    s_nop 0
    buffer_load_dwordx4 v20, s[24:27], s37 offen offset:0 lds
    buffer_load_dwordx4 v21, s[24:27], s37 offen offset:1024 lds
    buffer_load_dwordx4 v22, s[24:27], s37 offen offset:2048 lds
    s_add_u32 s60, s60, 1
    s_cmp_eq_u32 s60, 4
    s_cselect_b32 s60, 0, s60
    s_add_u32 s61, s61, 1
    s_cmp_eq_u32 s61, 4
    s_cselect_b32 s16, 4, 0
    s_cselect_b32 s61, 0, s61
    s_add_u32 s62, s62, s16
    s_add_u32 s16, s62, s60
    s_mul_i32 s37, s16, 458752
    s_lshl_b32 s38, s16, 7
    s_mul_i32 s16, s42, 7168
    v_min_u32 v10, 55, v0
    v_lshlrev_b32 v10, 7, v10
    v_add_u32 v10, s16, v10
    s_waitcnt vmcnt(11)
    s_barrier
    s_add_u32 m0, s43, 57344
    s_nop 0
    buffer_load_dwordx4 v24, s[20:23], s38 offen offset:0 lds
    buffer_load_dwordx4 v25, s[20:23], s38 offen offset:1024 lds
    buffer_load_dwordx4 v26, s[20:23], s38 offen offset:2048 lds
    buffer_load_dwordx4 v27, s[20:23], s38 offen offset:3072 lds
    s_add_u32 m0, s36, 0
    s_nop 0
    buffer_load_dwordx4 v16, s[24:27], s37 offen offset:0 lds
    buffer_load_dwordx4 v17, s[24:27], s37 offen offset:1024 lds
    buffer_load_dwordx4 v18, s[24:27], s37 offen offset:2048 lds
    buffer_load_dwordx4 v19, s[24:27], s37 offen offset:3072 lds
    s_add_u32 m0, s36, 4096
    s_nop 0
    buffer_load_dwordx4 v20, s[24:27], s37 offen offset:0 lds
    buffer_load_dwordx4 v21, s[24:27], s37 offen offset:1024 lds
    buffer_load_dwordx4 v22, s[24:27], s37 offen offset:2048 lds
    s_add_u32 s60, s60, 1
    s_cmp_eq_u32 s60, 4
    s_cselect_b32 s60, 0, s60
    s_add_u32 s61, s61, 1
    s_cmp_eq_u32 s61, 4
    s_cselect_b32 s16, 4, 0
    s_cselect_b32 s61, 0, s61
    s_add_u32 s62, s62, s16
    s_add_u32 s16, s62, s60
    s_mul_i32 s37, s16, 458752
    s_lshl_b32 s38, s16, 7
    s_waitcnt vmcnt(11)
    s_barrier
    s_add_u32 m0, s43, 73728
    s_nop 0
    buffer_load_dwordx4 v24, s[20:23], s38 offen offset:0 lds
    buffer_load_dwordx4 v25, s[20:23], s38 offen offset:1024 lds
    buffer_load_dwordx4 v26, s[20:23], s38 offen offset:2048 lds
    buffer_load_dwordx4 v27, s[20:23], s38 offen offset:3072 lds
    s_add_u32 m0, s36, 28672
    s_nop 0
    buffer_load_dwordx4 v16, s[24:27], s37 offen offset:0 lds
    buffer_load_dwordx4 v17, s[24:27], s37 offen offset:1024 lds
    buffer_load_dwordx4 v18, s[24:27], s37 offen offset:2048 lds
    buffer_load_dwordx4 v19, s[24:27], s37 offen offset:3072 lds
    s_add_u32 m0, s36, 32768
    s_nop 0
    buffer_load_dwordx4 v20, s[24:27], s37 offen offset:0 lds
    buffer_load_dwordx4 v21, s[24:27], s37 offen offset:1024 lds
    buffer_load_dwordx4 v22, s[24:27], s37 offen offset:2048 lds
    s_add_u32 s60, s60, 1
    s_cmp_eq_u32 s60, 4
    s_cselect_b32 s60, 0, s60
    s_add_u32 s61, s61, 1
    s_cmp_eq_u32 s61, 4
    s_cselect_b32 s16, 4, 0
    s_cselect_b32 s61, 0, s61
    s_add_u32 s62, s62, s16
    s_add_u32 s16, s62, s60
    s_mul_i32 s37, s16, 458752
    s_lshl_b32 s38, s16, 7
    s_waitcnt vmcnt(11)
    s_barrier
    s_add_u32 m0, s43, 90112
    s_nop 0
    buffer_load_dwordx4 v24, s[20:23], s38 offen offset:0 lds
    buffer_load_dwordx4 v25, s[20:23], s38 offen offset:1024 lds
    buffer_load_dwordx4 v26, s[20:23], s38 offen offset:2048 lds
    buffer_load_dwordx4 v27, s[20:23], s38 offen offset:3072 lds
    s_add_u32 m0, s36, 106496
    s_nop 0
    buffer_load_dwordx4 v16, s[24:27], s37 offen offset:0 lds
    buffer_load_dwordx4 v17, s[24:27], s37 offen offset:1024 lds
    buffer_load_dwordx4 v18, s[24:27], s37 offen offset:2048 lds
    buffer_load_dwordx4 v19, s[24:27], s37 offen offset:3072 lds
    s_add_u32 m0, s36, 110592
    s_nop 0
    buffer_load_dwordx4 v20, s[24:27], s37 offen offset:0 lds
    buffer_load_dwordx4 v21, s[24:27], s37 offen offset:1024 lds
    buffer_load_dwordx4 v22, s[24:27], s37 offen offset:2048 lds
    s_add_u32 s60, s60, 1
    s_cmp_eq_u32 s60, 4
    s_cselect_b32 s60, 0, s60
    s_add_u32 s61, s61, 1
    s_cmp_eq_u32 s61, 4
    s_cselect_b32 s16, 4, 0
    s_cselect_b32 s61, 0, s61
    s_add_u32 s62, s62, s16
    s_add_u32 s16, s62, s60
    s_mul_i32 s37, s16, 458752
    s_lshl_b32 s38, s16, 7
    s_waitcnt vmcnt(11)
    s_barrier
    s_add_u32 m0, s43, 57344
    s_nop 0
    buffer_load_dwordx4 v24, s[20:23], s38 offen offset:0 lds
    buffer_load_dwordx4 v25, s[20:23], s38 offen offset:1024 lds
    buffer_load_dwordx4 v26, s[20:23], s38 offen offset:2048 lds
    buffer_load_dwordx4 v27, s[20:23], s38 offen offset:3072 lds
    s_add_u32 m0, s36, 0
    s_nop 0
    buffer_load_dwordx4 v16, s[24:27], s37 offen offset:0 lds
    buffer_load_dwordx4 v17, s[24:27], s37 offen offset:1024 lds
    buffer_load_dwordx4 v18, s[24:27], s37 offen offset:2048 lds
    buffer_load_dwordx4 v19, s[24:27], s37 offen offset:3072 lds
    s_add_u32 m0, s36, 4096
    s_nop 0
    buffer_load_dwordx4 v20, s[24:27], s37 offen offset:0 lds
    buffer_load_dwordx4 v21, s[24:27], s37 offen offset:1024 lds
    buffer_load_dwordx4 v22, s[24:27], s37 offen offset:2048 lds
    s_add_u32 s60, s60, 1
    s_cmp_eq_u32 s60, 4
    s_cselect_b32 s60, 0, s60
    s_add_u32 s61, s61, 1
    s_cmp_eq_u32 s61, 4
    s_cselect_b32 s16, 4, 0
    s_cselect_b32 s61, 0, s61
    s_add_u32 s62, s62, s16
    s_add_u32 s16, s62, s60
    s_mul_i32 s37, s16, 458752
    s_lshl_b32 s38, s16, 7
    s_waitcnt vmcnt(11)
    s_barrier
    s_add_u32 m0, s43, 73728
    s_nop 0
    buffer_load_dwordx4 v24, s[20:23], s38 offen offset:0 lds
    buffer_load_dwordx4 v25, s[20:23], s38 offen offset:1024 lds
    buffer_load_dwordx4 v26, s[20:23], s38 offen offset:2048 lds
    buffer_load_dwordx4 v27, s[20:23], s38 offen offset:3072 lds
    s_add_u32 m0, s36, 28672
    s_nop 0
    buffer_load_dwordx4 v16, s[24:27], s37 offen offset:0 lds
    buffer_load_dwordx4 v17, s[24:27], s37 offen offset:1024 lds
    buffer_load_dwordx4 v18, s[24:27], s37 offen offset:2048 lds
    buffer_load_dwordx4 v19, s[24:27], s37 offen offset:3072 lds
    s_add_u32 m0, s36, 32768
    s_nop 0
    buffer_load_dwordx4 v20, s[24:27], s37 offen offset:0 lds
    buffer_load_dwordx4 v21, s[24:27], s37 offen offset:1024 lds
    buffer_load_dwordx4 v22, s[24:27], s37 offen offset:2048 lds
    s_add_u32 s60, s60, 1
    s_cmp_eq_u32 s60, 4
    s_cselect_b32 s60, 0, s60
    s_add_u32 s61, s61, 1
    s_cmp_eq_u32 s61, 4
    s_cselect_b32 s16, 4, 0
    s_cselect_b32 s61, 0, s61
    s_add_u32 s62, s62, s16
    s_add_u32 s16, s62, s60
    s_mul_i32 s37, s16, 458752
    s_lshl_b32 s38, s16, 7
    s_waitcnt vmcnt(11)
    s_barrier
    s_add_u32 m0, s43, 90112
    s_nop 0
    buffer_load_dwordx4 v24, s[20:23], s38 offen offset:0 lds
    buffer_load_dwordx4 v25, s[20:23], s38 offen offset:1024 lds
    buffer_load_dwordx4 v26, s[20:23], s38 offen offset:2048 lds
    buffer_load_dwordx4 v27, s[20:23], s38 offen offset:3072 lds
    s_add_u32 m0, s36, 106496
    s_nop 0
    buffer_load_dwordx4 v16, s[24:27], s37 offen offset:0 lds
    buffer_load_dwordx4 v17, s[24:27], s37 offen offset:1024 lds
    buffer_load_dwordx4 v18, s[24:27], s37 offen offset:2048 lds
    buffer_load_dwordx4 v19, s[24:27], s37 offen offset:3072 lds
    s_add_u32 m0, s36, 110592
    s_nop 0
    buffer_load_dwordx4 v20, s[24:27], s37 offen offset:0 lds
    buffer_load_dwordx4 v21, s[24:27], s37 offen offset:1024 lds
    buffer_load_dwordx4 v22, s[24:27], s37 offen offset:2048 lds
    s_add_u32 s60, s60, 1
    s_cmp_eq_u32 s60, 4
    s_cselect_b32 s60, 0, s60
    s_add_u32 s61, s61, 1
    s_cmp_eq_u32 s61, 4
    s_cselect_b32 s16, 4, 0
    s_cselect_b32 s61, 0, s61
    s_add_u32 s62, s62, s16
    s_add_u32 s16, s62, s60
    s_mul_i32 s37, s16, 458752
    s_lshl_b32 s38, s16, 7
    s_waitcnt vmcnt(11)
    s_barrier
    s_add_u32 m0, s43, 57344
    s_nop 0
    buffer_load_dwordx4 v24, s[20:23], s38 offen offset:0 lds
    buffer_load_dwordx4 v25, s[20:23], s38 offen offset:1024 lds
    buffer_load_dwordx4 v26, s[20:23], s38 offen offset:2048 lds
    buffer_load_dwordx4 v27, s[20:23], s38 offen offset:3072 lds
    s_add_u32 m0, s36, 0
    s_nop 0
    buffer_load_dwordx4 v16, s[24:27], s37 offen offset:0 lds
    buffer_load_dwordx4 v17, s[24:27], s37 offen offset:1024 lds
    buffer_load_dwordx4 v18, s[24:27], s37 offen offset:2048 lds
    buffer_load_dwordx4 v19, s[24:27], s37 offen offset:3072 lds
    s_add_u32 m0, s36, 4096
    s_nop 0
    buffer_load_dwordx4 v20, s[24:27], s37 offen offset:0 lds
    buffer_load_dwordx4 v21, s[24:27], s37 offen offset:1024 lds
    buffer_load_dwordx4 v22, s[24:27], s37 offen offset:2048 lds
    s_add_u32 s60, s60, 1
    s_cmp_eq_u32 s60, 4
    s_cselect_b32 s60, 0, s60
    s_add_u32 s61, s61, 1
    s_cmp_eq_u32 s61, 4
    s_cselect_b32 s16, 4, 0
    s_cselect_b32 s61, 0, s61
    s_add_u32 s62, s62, s16
    s_add_u32 s16, s62, s60
    s_mul_i32 s37, s16, 458752
    s_lshl_b32 s38, s16, 7
    s_waitcnt vmcnt(11)
    s_barrier
    s_add_u32 m0, s43, 73728
    s_nop 0
    buffer_load_dwordx4 v24, s[20:23], s38 offen offset:0 lds
    buffer_load_dwordx4 v25, s[20:23], s38 offen offset:1024 lds
    buffer_load_dwordx4 v26, s[20:23], s38 offen offset:2048 lds
    buffer_load_dwordx4 v27, s[20:23], s38 offen offset:3072 lds
    s_add_u32 m0, s36, 28672
    s_nop 0
    buffer_load_dwordx4 v16, s[24:27], s37 offen offset:0 lds
    buffer_load_dwordx4 v17, s[24:27], s37 offen offset:1024 lds
    buffer_load_dwordx4 v18, s[24:27], s37 offen offset:2048 lds
    buffer_load_dwordx4 v19, s[24:27], s37 offen offset:3072 lds
    s_add_u32 m0, s36, 32768
    s_nop 0
    buffer_load_dwordx4 v20, s[24:27], s37 offen offset:0 lds
    buffer_load_dwordx4 v21, s[24:27], s37 offen offset:1024 lds
    buffer_load_dwordx4 v22, s[24:27], s37 offen offset:2048 lds
    s_add_u32 s60, s60, 1
    s_cmp_eq_u32 s60, 4
    s_cselect_b32 s60, 0, s60
    s_add_u32 s61, s61, 1
    s_cmp_eq_u32 s61, 4
    s_cselect_b32 s16, 4, 0
    s_cselect_b32 s61, 0, s61
    s_add_u32 s62, s62, s16
    s_add_u32 s16, s62, s60
    s_mul_i32 s37, s16, 458752
    s_lshl_b32 s38, s16, 7
    s_waitcnt vmcnt(11)
    s_barrier
    s_add_u32 m0, s43, 90112
    s_nop 0
    buffer_load_dwordx4 v24, s[20:23], s38 offen offset:0 lds
    buffer_load_dwordx4 v25, s[20:23], s38 offen offset:1024 lds
    buffer_load_dwordx4 v26, s[20:23], s38 offen offset:2048 lds
    buffer_load_dwordx4 v27, s[20:23], s38 offen offset:3072 lds
    s_add_u32 m0, s36, 106496
    s_nop 0
    buffer_load_dwordx4 v16, s[24:27], s37 offen offset:0 lds
    buffer_load_dwordx4 v17, s[24:27], s37 offen offset:1024 lds
    buffer_load_dwordx4 v18, s[24:27], s37 offen offset:2048 lds
    buffer_load_dwordx4 v19, s[24:27], s37 offen offset:3072 lds
    s_add_u32 m0, s36, 110592
    s_nop 0
    buffer_load_dwordx4 v20, s[24:27], s37 offen offset:0 lds
    buffer_load_dwordx4 v21, s[24:27], s37 offen offset:1024 lds
    buffer_load_dwordx4 v22, s[24:27], s37 offen offset:2048 lds
    s_add_u32 s60, s60, 1
    s_cmp_eq_u32 s60, 4
    s_cselect_b32 s60, 0, s60
    s_add_u32 s61, s61, 1
    s_cmp_eq_u32 s61, 4
    s_cselect_b32 s16, 4, 0
    s_cselect_b32 s61, 0, s61
    s_add_u32 s62, s62, s16
    s_add_u32 s16, s62, s60
    s_mul_i32 s37, s16, 458752
    s_lshl_b32 s38, s16, 7
    s_waitcnt vmcnt(11)
    s_barrier
    s_add_u32 m0, s43, 57344
    s_nop 0
    buffer_load_dwordx4 v24, s[20:23], s38 offen offset:0 lds
    buffer_load_dwordx4 v25, s[20:23], s38 offen offset:1024 lds
    buffer_load_dwordx4 v26, s[20:23], s38 offen offset:2048 lds
    buffer_load_dwordx4 v27, s[20:23], s38 offen offset:3072 lds
    s_add_u32 m0, s36, 0
    s_nop 0
    buffer_load_dwordx4 v16, s[24:27], s37 offen offset:0 lds
    buffer_load_dwordx4 v17, s[24:27], s37 offen offset:1024 lds
    buffer_load_dwordx4 v18, s[24:27], s37 offen offset:2048 lds
    buffer_load_dwordx4 v19, s[24:27], s37 offen offset:3072 lds
    s_add_u32 m0, s36, 4096
    s_nop 0
    buffer_load_dwordx4 v20, s[24:27], s37 offen offset:0 lds
    buffer_load_dwordx4 v21, s[24:27], s37 offen offset:1024 lds
    buffer_load_dwordx4 v22, s[24:27], s37 offen offset:2048 lds
    s_add_u32 s60, s60, 1
    s_cmp_eq_u32 s60, 4
    s_cselect_b32 s60, 0, s60
    s_add_u32 s61, s61, 1
    s_cmp_eq_u32 s61, 4
    s_cselect_b32 s16, 4, 0
    s_cselect_b32 s61, 0, s61
    s_add_u32 s62, s62, s16
    s_add_u32 s16, s62, s60
    s_mul_i32 s37, s16, 458752
    s_lshl_b32 s38, s16, 7
    s_waitcnt vmcnt(11)
    s_barrier
    s_add_u32 m0, s43, 73728
    s_nop 0
    buffer_load_dwordx4 v24, s[20:23], s38 offen offset:0 lds
    buffer_load_dwordx4 v25, s[20:23], s38 offen offset:1024 lds
    buffer_load_dwordx4 v26, s[20:23], s38 offen offset:2048 lds
    buffer_load_dwordx4 v27, s[20:23], s38 offen offset:3072 lds
    s_add_u32 m0, s36, 28672
    s_nop 0
    buffer_load_dwordx4 v16, s[24:27], s37 offen offset:0 lds
    buffer_load_dwordx4 v17, s[24:27], s37 offen offset:1024 lds
    buffer_load_dwordx4 v18, s[24:27], s37 offen offset:2048 lds
    buffer_load_dwordx4 v19, s[24:27], s37 offen offset:3072 lds
    s_add_u32 m0, s36, 32768
    s_nop 0
    buffer_load_dwordx4 v20, s[24:27], s37 offen offset:0 lds
    buffer_load_dwordx4 v21, s[24:27], s37 offen offset:1024 lds
    buffer_load_dwordx4 v22, s[24:27], s37 offen offset:2048 lds
    s_add_u32 s60, s60, 1
    s_cmp_eq_u32 s60, 4
    s_cselect_b32 s60, 0, s60
    s_add_u32 s61, s61, 1
    s_cmp_eq_u32 s61, 4
    s_cselect_b32 s16, 4, 0
    s_cselect_b32 s61, 0, s61
    s_add_u32 s62, s62, s16
    s_add_u32 s16, s62, s60
    s_mul_i32 s37, s16, 458752
    s_lshl_b32 s38, s16, 7
    s_waitcnt vmcnt(11)
    s_barrier
    s_add_u32 m0, s43, 90112
    s_nop 0
    buffer_load_dwordx4 v24, s[20:23], s38 offen offset:0 lds
    buffer_load_dwordx4 v25, s[20:23], s38 offen offset:1024 lds
    buffer_load_dwordx4 v26, s[20:23], s38 offen offset:2048 lds
    buffer_load_dwordx4 v27, s[20:23], s38 offen offset:3072 lds
    s_add_u32 m0, s36, 106496
    s_nop 0
    buffer_load_dwordx4 v16, s[24:27], s37 offen offset:0 lds
    buffer_load_dwordx4 v17, s[24:27], s37 offen offset:1024 lds
    buffer_load_dwordx4 v18, s[24:27], s37 offen offset:2048 lds
    buffer_load_dwordx4 v19, s[24:27], s37 offen offset:3072 lds
    s_add_u32 m0, s36, 110592
    s_nop 0
    buffer_load_dwordx4 v20, s[24:27], s37 offen offset:0 lds
    buffer_load_dwordx4 v21, s[24:27], s37 offen offset:1024 lds
    buffer_load_dwordx4 v22, s[24:27], s37 offen offset:2048 lds
    s_add_u32 s60, s60, 1
    s_cmp_eq_u32 s60, 4
    s_cselect_b32 s60, 0, s60
    s_add_u32 s61, s61, 1
    s_cmp_eq_u32 s61, 4
    s_cselect_b32 s16, 4, 0
    s_cselect_b32 s61, 0, s61
    s_add_u32 s62, s62, s16
    s_add_u32 s16, s62, s60
    s_mul_i32 s37, s16, 458752
    s_lshl_b32 s38, s16, 7
    s_waitcnt vmcnt(11)
    s_barrier
    s_add_u32 m0, s43, 57344
    s_nop 0
    buffer_load_dwordx4 v24, s[20:23], s38 offen offset:0 lds
    buffer_load_dwordx4 v25, s[20:23], s38 offen offset:1024 lds
    buffer_load_dwordx4 v26, s[20:23], s38 offen offset:2048 lds
    buffer_load_dwordx4 v27, s[20:23], s38 offen offset:3072 lds
    s_add_u32 m0, s36, 0
    s_nop 0
    buffer_load_dwordx4 v16, s[24:27], s37 offen offset:0 lds
    buffer_load_dwordx4 v17, s[24:27], s37 offen offset:1024 lds
    buffer_load_dwordx4 v18, s[24:27], s37 offen offset:2048 lds
    buffer_load_dwordx4 v19, s[24:27], s37 offen offset:3072 lds
    s_add_u32 m0, s36, 4096
    s_nop 0
    buffer_load_dwordx4 v20, s[24:27], s37 offen offset:0 lds
    buffer_load_dwordx4 v21, s[24:27], s37 offen offset:1024 lds
    buffer_load_dwordx4 v22, s[24:27], s37 offen offset:2048 lds
    s_add_u32 s60, s60, 1
    s_cmp_eq_u32 s60, 4
    s_cselect_b32 s60, 0, s60
    s_add_u32 s61, s61, 1
    s_cmp_eq_u32 s61, 4
    s_cselect_b32 s16, 4, 0
    s_cselect_b32 s61, 0, s61
    s_add_u32 s62, s62, s16
    s_add_u32 s16, s62, s60
    s_mul_i32 s37, s16, 458752
    s_lshl_b32 s38, s16, 7
    buffer_load_dword v11, v10, s[52:55], 0 offen
    v_add_u32 v10, 7168, v10
    s_waitcnt vmcnt(12)
    s_barrier
    s_add_u32 s17, s94, s97
    s_add_u32 s17, s17, 0
    s_lshl_b32 s98, s17, 16
    s_add_u32 m0, s86, 0
    s_nop 0
    buffer_load_dwordx4 v28, s[52:55], s98 offen offset:0 lds
    buffer_load_dwordx4 v29, s[52:55], s98 offen offset:1024 lds
    buffer_load_dwordx4 v30, s[52:55], s98 offen offset:2048 lds
    buffer_load_dwordx4 v31, s[52:55], s98 offen offset:3072 lds
    s_waitcnt vmcnt(5)
    s_barrier
    s_add_u32 s17, s94, s97
    s_add_u32 s17, s17, 2
    s_lshl_b32 s98, s17, 16
    s_add_u32 m0, s86, 16384
    s_nop 0
    buffer_load_dwordx4 v28, s[52:55], s98 offen offset:0 lds
    buffer_load_dwordx4 v29, s[52:55], s98 offen offset:1024 lds
    buffer_load_dwordx4 v30, s[52:55], s98 offen offset:2048 lds
    buffer_load_dwordx4 v31, s[52:55], s98 offen offset:3072 lds
    s_add_u32 s17, s94, s97
    s_add_u32 s17, s17, 4
    s_lshl_b32 s98, s17, 16
    s_add_u32 m0, s86, 32768
    s_nop 0
    buffer_load_dwordx4 v28, s[52:55], s98 offen offset:0 lds
    buffer_load_dwordx4 v29, s[52:55], s98 offen offset:1024 lds
    buffer_load_dwordx4 v30, s[52:55], s98 offen offset:2048 lds
    buffer_load_dwordx4 v31, s[52:55], s98 offen offset:3072 lds
    s_cmp_ge_u32 s96, s94
    s_cselect_b32 s17, 7, 0
    s_add_u32 s17, s17, s96
    s_lshl_b32 s98, s17, 16
    s_add_u32 s17, s94, 6
    s_lshl_b32 s17, s17, 16
    s_cmp_eq_u32 s97, 0
    s_cselect_b32 s98, s17, s98
    s_add_u32 s96, s96, 2
    s_add_u32 m0, s86, 49152
    s_nop 0
    buffer_load_dwordx4 v28, s[52:55], s98 offen offset:0 lds
    buffer_load_dwordx4 v29, s[52:55], s98 offen offset:1024 lds
    buffer_load_dwordx4 v30, s[52:55], s98 offen offset:2048 lds
    buffer_load_dwordx4 v31, s[52:55], s98 offen offset:3072 lds
    s_waitcnt vmcnt(12)
    s_barrier
    s_waitcnt vmcnt(8)
    s_barrier
    s_cmp_ge_u32 s96, s94
    s_cselect_b32 s17, 7, 0
    s_add_u32 s17, s17, s96
    s_lshl_b32 s98, s17, 16
    s_add_u32 s96, s96, 2
    s_add_u32 m0, s86, 0
    s_nop 0
    buffer_load_dwordx4 v28, s[52:55], s98 offen offset:0 lds
    buffer_load_dwordx4 v29, s[52:55], s98 offen offset:1024 lds
    buffer_load_dwordx4 v30, s[52:55], s98 offen offset:2048 lds
    buffer_load_dwordx4 v31, s[52:55], s98 offen offset:3072 lds
    s_waitcnt vmcnt(8)
    s_barrier
    s_cmp_ge_u32 s96, s94
    s_cselect_b32 s17, 7, 0
    s_add_u32 s17, s17, s96
    s_lshl_b32 s98, s17, 16
    s_add_u32 s96, s96, 2
    s_add_u32 m0, s86, 16384
    s_nop 0
    buffer_load_dwordx4 v28, s[52:55], s98 offen offset:0 lds
    buffer_load_dwordx4 v29, s[52:55], s98 offen offset:1024 lds
    buffer_load_dwordx4 v30, s[52:55], s98 offen offset:2048 lds
    buffer_load_dwordx4 v31, s[52:55], s98 offen offset:3072 lds
    s_waitcnt vmcnt(8)
    s_barrier
    s_cmp_ge_u32 s96, s94
    s_cselect_b32 s17, 7, 0
    s_add_u32 s17, s17, s96
    s_lshl_b32 s98, s17, 16
    s_add_u32 s96, s96, 2
    s_add_u32 m0, s86, 32768
    s_nop 0
    buffer_load_dwordx4 v28, s[52:55], s98 offen offset:0 lds
    buffer_load_dwordx4 v29, s[52:55], s98 offen offset:1024 lds
    buffer_load_dwordx4 v30, s[52:55], s98 offen offset:2048 lds
    buffer_load_dwordx4 v31, s[52:55], s98 offen offset:3072 lds
    s_waitcnt vmcnt(8)
    s_barrier
    s_cmp_ge_u32 s96, s94
    s_cselect_b32 s17, 7, 0
    s_add_u32 s17, s17, s96
    s_lshl_b32 s98, s17, 16
    s_add_u32 s96, s96, 2
    s_add_u32 m0, s86, 49152
    s_nop 0
    buffer_load_dwordx4 v28, s[52:55], s98 offen offset:0 lds
    buffer_load_dwordx4 v29, s[52:55], s98 offen offset:1024 lds
    buffer_load_dwordx4 v30, s[52:55], s98 offen offset:2048 lds
    buffer_load_dwordx4 v31, s[52:55], s98 offen offset:3072 lds
    s_waitcnt vmcnt(8)
    s_barrier
    s_cmp_ge_u32 s96, s94
    s_cselect_b32 s17, 7, 0
    s_add_u32 s17, s17, s96
    s_lshl_b32 s98, s17, 16
    s_add_u32 s96, s96, 2
    s_add_u32 m0, s86, 0
    s_nop 0
    buffer_load_dwordx4 v28, s[52:55], s98 offen offset:0 lds
    buffer_load_dwordx4 v29, s[52:55], s98 offen offset:1024 lds
    buffer_load_dwordx4 v30, s[52:55], s98 offen offset:2048 lds
    buffer_load_dwordx4 v31, s[52:55], s98 offen offset:3072 lds
    s_waitcnt vmcnt(8)
    s_barrier
    s_cmp_ge_u32 s96, s94
    s_cselect_b32 s17, 7, 0
    s_add_u32 s17, s17, s96
    s_lshl_b32 s98, s17, 16
    s_add_u32 s96, s96, 2
    s_add_u32 m0, s86, 16384
    s_nop 0
    buffer_load_dwordx4 v28, s[52:55], s98 offen offset:0 lds
    buffer_load_dwordx4 v29, s[52:55], s98 offen offset:1024 lds
    buffer_load_dwordx4 v30, s[52:55], s98 offen offset:2048 lds
    buffer_load_dwordx4 v31, s[52:55], s98 offen offset:3072 lds
    s_waitcnt vmcnt(8)
    s_barrier
    s_cmp_ge_u32 s96, s94
    s_cselect_b32 s17, 7, 0
    s_add_u32 s17, s17, s96
    s_lshl_b32 s98, s17, 16
    s_add_u32 s96, s96, 2
    s_add_u32 m0, s86, 32768
    s_nop 0
    buffer_load_dwordx4 v28, s[52:55], s98 offen offset:0 lds
    buffer_load_dwordx4 v29, s[52:55], s98 offen offset:1024 lds
    buffer_load_dwordx4 v30, s[52:55], s98 offen offset:2048 lds
    buffer_load_dwordx4 v31, s[52:55], s98 offen offset:3072 lds
    s_waitcnt vmcnt(8)
    s_barrier
    s_cmp_ge_u32 s96, s94
    s_cselect_b32 s17, 7, 0
    s_add_u32 s17, s17, s96
    s_lshl_b32 s98, s17, 16
    s_add_u32 s96, s96, 2
    s_add_u32 m0, s86, 49152
    s_nop 0
    buffer_load_dwordx4 v28, s[52:55], s98 offen offset:0 lds
    buffer_load_dwordx4 v29, s[52:55], s98 offen offset:1024 lds
    buffer_load_dwordx4 v30, s[52:55], s98 offen offset:2048 lds
    buffer_load_dwordx4 v31, s[52:55], s98 offen offset:3072 lds
    s_waitcnt vmcnt(8)
    s_barrier
    s_cmp_ge_u32 s96, s94
    s_cselect_b32 s17, 7, 0
    s_add_u32 s17, s17, s96
    s_lshl_b32 s98, s17, 16
    s_add_u32 s96, s96, 2
    s_add_u32 m0, s86, 0
    s_nop 0
    buffer_load_dwordx4 v28, s[52:55], s98 offen offset:0 lds
    buffer_load_dwordx4 v29, s[52:55], s98 offen offset:1024 lds
    buffer_load_dwordx4 v30, s[52:55], s98 offen offset:2048 lds
    buffer_load_dwordx4 v31, s[52:55], s98 offen offset:3072 lds
    s_waitcnt vmcnt(8)
    s_barrier
    s_cmp_ge_u32 s96, s94
    s_cselect_b32 s17, 7, 0
    s_add_u32 s17, s17, s96
    s_lshl_b32 s98, s17, 16
    s_add_u32 s96, s96, 2
    s_add_u32 m0, s86, 16384
    s_nop 0
    buffer_load_dwordx4 v28, s[52:55], s98 offen offset:0 lds
    buffer_load_dwordx4 v29, s[52:55], s98 offen offset:1024 lds
    buffer_load_dwordx4 v30, s[52:55], s98 offen offset:2048 lds
    buffer_load_dwordx4 v31, s[52:55], s98 offen offset:3072 lds
    s_waitcnt vmcnt(8)
    s_barrier
    s_cmp_ge_u32 s96, s94
    s_cselect_b32 s17, 7, 0
    s_add_u32 s17, s17, s96
    s_lshl_b32 s98, s17, 16
    s_add_u32 s96, s96, 2
    s_add_u32 m0, s86, 32768
    s_nop 0
    buffer_load_dwordx4 v28, s[52:55], s98 offen offset:0 lds
    buffer_load_dwordx4 v29, s[52:55], s98 offen offset:1024 lds
    buffer_load_dwordx4 v30, s[52:55], s98 offen offset:2048 lds
    buffer_load_dwordx4 v31, s[52:55], s98 offen offset:3072 lds
    s_waitcnt vmcnt(8)
    s_barrier
    s_cmp_ge_u32 s96, s94
    s_cselect_b32 s17, 7, 0
    s_add_u32 s17, s17, s96
    s_lshl_b32 s98, s17, 16
    s_add_u32 s96, s96, 2
    s_add_u32 m0, s86, 49152
    s_nop 0
    buffer_load_dwordx4 v28, s[52:55], s98 offen offset:0 lds
    buffer_load_dwordx4 v29, s[52:55], s98 offen offset:1024 lds
    buffer_load_dwordx4 v30, s[52:55], s98 offen offset:2048 lds
    buffer_load_dwordx4 v31, s[52:55], s98 offen offset:3072 lds
    s_waitcnt vmcnt(8)
    s_barrier
    s_cmp_ge_u32 s96, s94
    s_cselect_b32 s17, 7, 0
    s_add_u32 s17, s17, s96
    s_lshl_b32 s98, s17, 16
    s_add_u32 s96, s96, 2
    s_add_u32 m0, s86, 0
    s_nop 0
    buffer_load_dwordx4 v28, s[52:55], s98 offen offset:0 lds
    buffer_load_dwordx4 v29, s[52:55], s98 offen offset:1024 lds
    buffer_load_dwordx4 v30, s[52:55], s98 offen offset:2048 lds
    buffer_load_dwordx4 v31, s[52:55], s98 offen offset:3072 lds
    s_waitcnt vmcnt(8)
    s_barrier
    s_cmp_ge_u32 s96, s94
    s_cselect_b32 s17, 7, 0
    s_add_u32 s17, s17, s96
    s_lshl_b32 s98, s17, 16
    s_add_u32 s96, s96, 2
    s_add_u32 m0, s86, 16384
    s_nop 0
    buffer_load_dwordx4 v28, s[52:55], s98 offen offset:0 lds
    buffer_load_dwordx4 v29, s[52:55], s98 offen offset:1024 lds
    buffer_load_dwordx4 v30, s[52:55], s98 offen offset:2048 lds
    buffer_load_dwordx4 v31, s[52:55], s98 offen offset:3072 lds
    s_waitcnt vmcnt(8)
    s_barrier
    s_cmp_ge_u32 s96, s94
    s_cselect_b32 s17, 7, 0
    s_add_u32 s17, s17, s96
    s_lshl_b32 s98, s17, 16
    s_add_u32 s96, s96, 2
    s_add_u32 m0, s86, 32768
    s_nop 0
    buffer_load_dwordx4 v28, s[52:55], s98 offen offset:0 lds
    buffer_load_dwordx4 v29, s[52:55], s98 offen offset:1024 lds
    buffer_load_dwordx4 v30, s[52:55], s98 offen offset:2048 lds
    buffer_load_dwordx4 v31, s[52:55], s98 offen offset:3072 lds
    s_waitcnt vmcnt(8)
    s_barrier
    s_cmp_ge_u32 s96, s94
    s_cselect_b32 s17, 7, 0
    s_add_u32 s17, s17, s96
    s_lshl_b32 s98, s17, 16
    s_add_u32 s96, s96, 2
    s_add_u32 m0, s86, 49152
    s_nop 0
    buffer_load_dwordx4 v28, s[52:55], s98 offen offset:0 lds
    buffer_load_dwordx4 v29, s[52:55], s98 offen offset:1024 lds
    buffer_load_dwordx4 v30, s[52:55], s98 offen offset:2048 lds
    buffer_load_dwordx4 v31, s[52:55], s98 offen offset:3072 lds
    s_waitcnt vmcnt(8)
    s_barrier
    s_cmp_ge_u32 s96, s94
    s_cselect_b32 s17, 7, 0
    s_add_u32 s17, s17, s96
    s_lshl_b32 s98, s17, 16
    s_add_u32 s96, s96, 2
    s_add_u32 m0, s86, 0
    s_nop 0
    buffer_load_dwordx4 v28, s[52:55], s98 offen offset:0 lds
    buffer_load_dwordx4 v29, s[52:55], s98 offen offset:1024 lds
    buffer_load_dwordx4 v30, s[52:55], s98 offen offset:2048 lds
    buffer_load_dwordx4 v31, s[52:55], s98 offen offset:3072 lds
    s_waitcnt vmcnt(8)
    s_barrier
    s_cmp_ge_u32 s96, s94
    s_cselect_b32 s17, 7, 0
    s_add_u32 s17, s17, s96
    s_lshl_b32 s98, s17, 16
    s_add_u32 s96, s96, 2
    s_add_u32 m0, s86, 16384
    s_nop 0
    buffer_load_dwordx4 v28, s[52:55], s98 offen offset:0 lds
    buffer_load_dwordx4 v29, s[52:55], s98 offen offset:1024 lds
    buffer_load_dwordx4 v30, s[52:55], s98 offen offset:2048 lds
    buffer_load_dwordx4 v31, s[52:55], s98 offen offset:3072 lds
    s_waitcnt vmcnt(8)
    s_barrier
    s_cmp_ge_u32 s96, s94
    s_cselect_b32 s17, 7, 0
    s_add_u32 s17, s17, s96
    s_lshl_b32 s98, s17, 16
    s_add_u32 s96, s96, 2
    s_add_u32 m0, s86, 32768
    s_nop 0
    buffer_load_dwordx4 v28, s[52:55], s98 offen offset:0 lds
    buffer_load_dwordx4 v29, s[52:55], s98 offen offset:1024 lds
    buffer_load_dwordx4 v30, s[52:55], s98 offen offset:2048 lds
    buffer_load_dwordx4 v31, s[52:55], s98 offen offset:3072 lds
    s_waitcnt vmcnt(8)
    s_barrier
    s_cmp_ge_u32 s96, s94
    s_cselect_b32 s17, 7, 0
    s_add_u32 s17, s17, s96
    s_lshl_b32 s98, s17, 16
    s_add_u32 s96, s96, 2
    s_add_u32 m0, s86, 49152
    s_nop 0
    buffer_load_dwordx4 v28, s[52:55], s98 offen offset:0 lds
    buffer_load_dwordx4 v29, s[52:55], s98 offen offset:1024 lds
    buffer_load_dwordx4 v30, s[52:55], s98 offen offset:2048 lds
    buffer_load_dwordx4 v31, s[52:55], s98 offen offset:3072 lds
    s_waitcnt vmcnt(8)
    s_barrier
    s_cmp_ge_u32 s96, s94
    s_cselect_b32 s17, 7, 0
    s_add_u32 s17, s17, s96
    s_lshl_b32 s98, s17, 16
    s_add_u32 s96, s96, 2
    s_add_u32 m0, s86, 0
    s_nop 0
    buffer_load_dwordx4 v28, s[52:55], s98 offen offset:0 lds
    buffer_load_dwordx4 v29, s[52:55], s98 offen offset:1024 lds
    buffer_load_dwordx4 v30, s[52:55], s98 offen offset:2048 lds
    buffer_load_dwordx4 v31, s[52:55], s98 offen offset:3072 lds
    s_waitcnt vmcnt(8)
    s_barrier
    s_cmp_ge_u32 s96, s94
    s_cselect_b32 s17, 7, 0
    s_add_u32 s17, s17, s96
    s_lshl_b32 s98, s17, 16
    s_add_u32 s96, s96, 2
    s_add_u32 m0, s86, 16384
    s_nop 0
    buffer_load_dwordx4 v28, s[52:55], s98 offen offset:0 lds
    buffer_load_dwordx4 v29, s[52:55], s98 offen offset:1024 lds
    buffer_load_dwordx4 v30, s[52:55], s98 offen offset:2048 lds
    buffer_load_dwordx4 v31, s[52:55], s98 offen offset:3072 lds
    s_waitcnt vmcnt(8)
    s_barrier
    s_cmp_ge_u32 s96, s94
    s_cselect_b32 s17, 7, 0
    s_add_u32 s17, s17, s96
    s_lshl_b32 s98, s17, 16
    s_add_u32 s96, s96, 2
    s_add_u32 m0, s86, 32768
    s_nop 0
    buffer_load_dwordx4 v28, s[52:55], s98 offen offset:0 lds
    buffer_load_dwordx4 v29, s[52:55], s98 offen offset:1024 lds
    buffer_load_dwordx4 v30, s[52:55], s98 offen offset:2048 lds
    buffer_load_dwordx4 v31, s[52:55], s98 offen offset:3072 lds
    s_waitcnt vmcnt(8)
    s_barrier
    s_cmp_ge_u32 s96, s94
    s_cselect_b32 s17, 7, 0
    s_add_u32 s17, s17, s96
    s_lshl_b32 s98, s17, 16
    s_add_u32 s96, s96, 2
    s_add_u32 m0, s86, 49152
    s_nop 0
    buffer_load_dwordx4 v28, s[52:55], s98 offen offset:0 lds
    buffer_load_dwordx4 v29, s[52:55], s98 offen offset:1024 lds
    buffer_load_dwordx4 v30, s[52:55], s98 offen offset:2048 lds
    buffer_load_dwordx4 v31, s[52:55], s98 offen offset:3072 lds
    s_waitcnt vmcnt(8)
    s_barrier
    s_waitcnt vmcnt(4)
    s_barrier
    s_waitcnt vmcnt(0)
    s_barrier
    s_waitcnt lgkmcnt(0)
    s_endpgm
L_main:
    s_lshl_b32 s16, s3, 9
    s_add_u32 m0, s16, 139264
    v_lshlrev_b32 v2, 2, v0
    v_lshlrev_b32 v6, 3, v3
    v_add_u32 v6, m0, v6
    s_mul_i32 s16, s13, 448
    s_waitcnt lgkmcnt(0)
    s_add_u32 s8, s8, s16
    s_addc_u32 s9, s9, 0
    s_mov_b32 s28, s8
    s_and_b32 s29, s9, 0xffff
    s_mov_b32 s30, 448
    s_mov_b32 s31, 0x20000
    buffer_load_dword v2, s[28:31], 0 offen lds
    buffer_load_dword v2, s[28:31], 0 offen offset:256 lds
    s_mov_b32 s48, s46
    s_and_b32 s49, s47, 0xffff
    s_mov_b32 s50, 67108864
    s_mov_b32 s51, 0x20000
    s_mov_b32 s56, s44
    s_and_b32 s57, s45, 0xffff
    s_mov_b32 s58, 256
    s_mov_b32 s59, 0x20000
    v_mov_b32 v7, 0
    s_or_b32 s16, s2, s3
    s_cmp_eq_u32 s16, 0
    s_cbranch_scc0 L_nn0
    s_load_dwordx2 s[92:93], s[46:47], 0
    s_waitcnt lgkmcnt(0)
    s_add_u32 s92, s92, 1
    s_or_b32 s93, s93, 1
    v_mov_b32 v4, s92
    v_mov_b32 v5, s93
    s_waitcnt vmcnt(0)
    buffer_store_dwordx2 v[4:5], v7, s[56:59], 0 offen sc1
    buffer_store_dwordx2 v[4:5], v7, s[48:51], 0 offen
    s_branch L_nn1
L_nn0:
    s_waitcnt vmcnt(0)
L_nn1:
    ds_read_b64 v[22:23], v6 offset:0
    ds_read_b64 v[30:31], v6 offset:32
    ds_read_b64 v[38:39], v6 offset:64
    ds_read_b64 v[46:47], v6 offset:96
    ds_read_b64 v[54:55], v6 offset:128
    ds_read_b64 v[62:63], v6 offset:160
    ds_read_b64 v[70:71], v6 offset:192
    ds_read_b64 v[78:79], v6 offset:224
    ds_read_b64 v[86:87], v6 offset:256
    ds_read_b64 v[94:95], v6 offset:288
    ds_read_b64 v[102:103], v6 offset:320
    ds_read_b64 v[110:111], v6 offset:352
    ds_read_b64 v[118:119], v6 offset:384
    ds_read_b64 v[126:127], v6 offset:416
    s_lshl_b32 s16, s19, 8
    s_lshl_b32 s17, s14, 7
    s_add_u32 s16, s16, s17
    s_add_u32 s88, s88, s16
    s_addc_u32 s89, s89, 0
    s_mov_b32 s28, s88
    s_and_b32 s29, s89, 0xffff
    s_mov_b32 s30, 128
    s_mov_b32 s31, 0x20000
    s_lshl_b32 s17, s12, 18
    s_add_u32 s16, s16, s17
    s_add_u32 s90, s90, s16
    s_addc_u32 s91, s91, 0
    s_sub_u32 s17, 4194304, s16
    s_mov_b32 s32, s90
    s_and_b32 s33, s91, 0xffff
    s_mov_b32 s34, s17
    s_mov_b32 s35, 0x20000
    s_mul_i32 s94, s13, 7
    s_mul_i32 s95, s14, 56
    s_mul_i32 s98, s12, 112*8192
    s_add_u32 s98, s98, 65536
    s_lshl_b32 s99, s94, 13
    s_add_u32 s99, s99, s98
    s_and_b32 s16, s2, 7
    s_lshl_b32 s16, s16, 2
    s_add_u32 s16, s16, s18
    s_lshl_b32 s16, s16, 2
    s_add_u32 s16, s16, s3
    s_lshl_b32 s16, s16, 7
    s_add_u32 s87, s16, 33554432
    s_lshl_b32 s16, s19, 3
    s_add_u32 s86, s87, s16
    v_lshrrev_b32 v2, 2, v0
    v_and_b32 v2, 3, v2
    v_lshl_add_u32 v2, v3, 3, v2
    v_mul_u32_u24 v2, 448, v2
    v_and_b32 v8, 3, v0
    v_lshl_add_u32 v2, v8, 3, v2
    v_and_b32 v8, 1, v3
    v_lshlrev_b32 v8, 5, v8
    v_add_u32 v10, v2, v8
    v_xor_b32 v8, 32, v8
    v_add_u32 v11, v2, v8
    v_add_u32 v12, 106496, v10
    v_add_u32 v13, 106496, v11
    s_lshl_b32 s16, s3, 12
    s_add_u32 s16, s16, 57344
    v_and_b32 v2, 15, v0
    v_lshrrev_b32 v8, 1, v2
    v_xor_b32 v8, v8, v3
    v_lshlrev_b32 v2, 7, v2
    v_lshl_add_u32 v2, v8, 4, v2
    v_add_u32 v14, s16, v2
    v_xor_b32 v15, 64, v14
    s_lshl_b32 s16, s3, 11
    v_lshlrev_b32 v1, 4, v0
    v_add_u32 v1, s16, v1
    s_waitcnt lgkmcnt(0)
    v_lshlrev_b32 v16, 16, v22
    v_and_b32 v17, 0xffff0000, v22
    v_lshlrev_b32 v18, 16, v23
    v_and_b32 v19, 0xffff0000, v23
    v_pk_mov_b32 v[20:21], v[16:17], v[16:17] op_sel:[0,1]
    v_pk_mov_b32 v[22:23], v[18:19], v[18:19] op_sel:[0,1]
    v_lshlrev_b32 v24, 16, v30
    v_and_b32 v25, 0xffff0000, v30
    v_lshlrev_b32 v26, 16, v31
    v_and_b32 v27, 0xffff0000, v31
    v_pk_mov_b32 v[28:29], v[24:25], v[24:25] op_sel:[0,1]
    v_pk_mov_b32 v[30:31], v[26:27], v[26:27] op_sel:[0,1]
    v_lshlrev_b32 v32, 16, v38
    v_and_b32 v33, 0xffff0000, v38
    v_lshlrev_b32 v34, 16, v39
    v_and_b32 v35, 0xffff0000, v39
    v_pk_mov_b32 v[36:37], v[32:33], v[32:33] op_sel:[0,1]
    v_pk_mov_b32 v[38:39], v[34:35], v[34:35] op_sel:[0,1]
    v_lshlrev_b32 v40, 16, v46
    v_and_b32 v41, 0xffff0000, v46
    v_lshlrev_b32 v42, 16, v47
    v_and_b32 v43, 0xffff0000, v47
    v_pk_mov_b32 v[44:45], v[40:41], v[40:41] op_sel:[0,1]
    v_pk_mov_b32 v[46:47], v[42:43], v[42:43] op_sel:[0,1]
    v_lshlrev_b32 v48, 16, v54
    v_and_b32 v49, 0xffff0000, v54
    v_lshlrev_b32 v50, 16, v55
    v_and_b32 v51, 0xffff0000, v55
    v_pk_mov_b32 v[52:53], v[48:49], v[48:49] op_sel:[0,1]
    v_pk_mov_b32 v[54:55], v[50:51], v[50:51] op_sel:[0,1]
    v_lshlrev_b32 v56, 16, v62
    v_and_b32 v57, 0xffff0000, v62
    v_lshlrev_b32 v58, 16, v63
    v_and_b32 v59, 0xffff0000, v63
    v_pk_mov_b32 v[60:61], v[56:57], v[56:57] op_sel:[0,1]
    v_pk_mov_b32 v[62:63], v[58:59], v[58:59] op_sel:[0,1]
    v_lshlrev_b32 v64, 16, v70
    v_and_b32 v65, 0xffff0000, v70
    v_lshlrev_b32 v66, 16, v71
    v_and_b32 v67, 0xffff0000, v71
    v_pk_mov_b32 v[68:69], v[64:65], v[64:65] op_sel:[0,1]
    v_pk_mov_b32 v[70:71], v[66:67], v[66:67] op_sel:[0,1]
    v_lshlrev_b32 v72, 16, v78
    v_and_b32 v73, 0xffff0000, v78
    v_lshlrev_b32 v74, 16, v79
    v_and_b32 v75, 0xffff0000, v79
    v_pk_mov_b32 v[76:77], v[72:73], v[72:73] op_sel:[0,1]
    v_pk_mov_b32 v[78:79], v[74:75], v[74:75] op_sel:[0,1]
    v_lshlrev_b32 v80, 16, v86
    v_and_b32 v81, 0xffff0000, v86
    v_lshlrev_b32 v82, 16, v87
    v_and_b32 v83, 0xffff0000, v87
    v_pk_mov_b32 v[84:85], v[80:81], v[80:81] op_sel:[0,1]
    v_pk_mov_b32 v[86:87], v[82:83], v[82:83] op_sel:[0,1]
    v_lshlrev_b32 v88, 16, v94
    v_and_b32 v89, 0xffff0000, v94
    v_lshlrev_b32 v90, 16, v95
    v_and_b32 v91, 0xffff0000, v95
    v_pk_mov_b32 v[92:93], v[88:89], v[88:89] op_sel:[0,1]
    v_pk_mov_b32 v[94:95], v[90:91], v[90:91] op_sel:[0,1]
    v_lshlrev_b32 v96, 16, v102
    v_and_b32 v97, 0xffff0000, v102
    v_lshlrev_b32 v98, 16, v103
    v_and_b32 v99, 0xffff0000, v103
    v_pk_mov_b32 v[100:101], v[96:97], v[96:97] op_sel:[0,1]
    v_pk_mov_b32 v[102:103], v[98:99], v[98:99] op_sel:[0,1]
    v_lshlrev_b32 v104, 16, v110
    v_and_b32 v105, 0xffff0000, v110
    v_lshlrev_b32 v106, 16, v111
    v_and_b32 v107, 0xffff0000, v111
    v_pk_mov_b32 v[108:109], v[104:105], v[104:105] op_sel:[0,1]
    v_pk_mov_b32 v[110:111], v[106:107], v[106:107] op_sel:[0,1]
    v_lshlrev_b32 v112, 16, v118
    v_and_b32 v113, 0xffff0000, v118
    v_lshlrev_b32 v114, 16, v119
    v_and_b32 v115, 0xffff0000, v119
    v_pk_mov_b32 v[116:117], v[112:113], v[112:113] op_sel:[0,1]
    v_pk_mov_b32 v[118:119], v[114:115], v[114:115] op_sel:[0,1]
    v_lshlrev_b32 v120, 16, v126
    v_and_b32 v121, 0xffff0000, v126
    v_lshlrev_b32 v122, 16, v127
    v_and_b32 v123, 0xffff0000, v127
    v_pk_mov_b32 v[124:125], v[120:121], v[120:121] op_sel:[0,1]
    v_pk_mov_b32 v[126:127], v[122:123], v[122:123] op_sel:[0,1]
    s_barrier
    ds_read_b128 a[112:115], v14 offset:0
    ds_read_b128 a[116:119], v14 offset:2048
    ds_read_b64_tr_b16 a[0:1], v10 offset:0
    ds_read_b64_tr_b16 a[2:3], v10 offset:1792
    ds_read_b64_tr_b16 a[4:5], v11 offset:0
    ds_read_b64_tr_b16 a[6:7], v11 offset:1792
    ds_read_b64_tr_b16 a[8:9], v10 offset:64
    ds_read_b64_tr_b16 a[10:11], v10 offset:1856
    ds_read_b64_tr_b16 a[12:13], v11 offset:64
    ds_read_b64_tr_b16 a[14:15], v11 offset:1856
    ds_read_b64_tr_b16 a[16:17], v10 offset:128
    ds_read_b64_tr_b16 a[18:19], v10 offset:1920
    ds_read_b64_tr_b16 a[20:21], v11 offset:128
    ds_read_b64_tr_b16 a[22:23], v11 offset:1920
    ds_read_b64_tr_b16 a[24:25], v10 offset:192
    ds_read_b64_tr_b16 a[26:27], v10 offset:1984
    ds_read_b64_tr_b16 a[28:29], v11 offset:192
    ds_read_b64_tr_b16 a[30:31], v11 offset:1984
    ds_read_b64_tr_b16 a[32:33], v10 offset:256
    ds_read_b64_tr_b16 a[34:35], v10 offset:2048
    ds_read_b64_tr_b16 a[36:37], v11 offset:256
    ds_read_b64_tr_b16 a[38:39], v11 offset:2048
    ds_read_b64_tr_b16 a[40:41], v10 offset:320
    ds_read_b64_tr_b16 a[42:43], v10 offset:2112
    ds_read_b64_tr_b16 a[44:45], v11 offset:320
    ds_read_b64_tr_b16 a[46:47], v11 offset:2112
    ds_read_b64_tr_b16 a[48:49], v10 offset:384
    ds_read_b64_tr_b16 a[50:51], v10 offset:2176
    ds_read_b64_tr_b16 a[52:53], v11 offset:384
    ds_read_b64_tr_b16 a[54:55], v11 offset:2176
    s_mov_b32 s39, 0
L1_loop:
    s_waitcnt lgkmcnt(0)
    v_mfma_f32_16x16x32_bf16 v[16:19], a[0:3], a[112:115], v[16:19]
    ds_read_b128 a[120:123], v15 offset:0
    ds_read_b128 a[124:127], v15 offset:2048
    v_mfma_f32_16x16x32_bf16 v[20:23], a[0:3], a[116:119], v[20:23]
    ds_read_b64_tr_b16 a[56:57], v10 offset:14336
    v_mfma_f32_16x16x32_bf16 v[24:27], a[4:7], a[112:115], v[24:27]
    ds_read_b64_tr_b16 a[58:59], v10 offset:16128
    ds_read_b64_tr_b16 a[60:61], v11 offset:14336
    v_mfma_f32_16x16x32_bf16 v[28:31], a[4:7], a[116:119], v[28:31]
    ds_read_b64_tr_b16 a[62:63], v11 offset:16128
    v_mfma_f32_16x16x32_bf16 v[32:35], a[8:11], a[112:115], v[32:35]
    ds_read_b64_tr_b16 a[64:65], v10 offset:14400
    ds_read_b64_tr_b16 a[66:67], v10 offset:16192
    v_mfma_f32_16x16x32_bf16 v[36:39], a[8:11], a[116:119], v[36:39]
    ds_read_b64_tr_b16 a[68:69], v11 offset:14400
    v_mfma_f32_16x16x32_bf16 v[40:43], a[12:15], a[112:115], v[40:43]
    ds_read_b64_tr_b16 a[70:71], v11 offset:16192
    ds_read_b64_tr_b16 a[72:73], v10 offset:14464
    v_mfma_f32_16x16x32_bf16 v[44:47], a[12:15], a[116:119], v[44:47]
    ds_read_b64_tr_b16 a[74:75], v10 offset:16256
    v_mfma_f32_16x16x32_bf16 v[48:51], a[16:19], a[112:115], v[48:51]
    ds_read_b64_tr_b16 a[76:77], v11 offset:14464
    ds_read_b64_tr_b16 a[78:79], v11 offset:16256
    v_mfma_f32_16x16x32_bf16 v[52:55], a[16:19], a[116:119], v[52:55]
    ds_read_b64_tr_b16 a[80:81], v10 offset:14528
    v_mfma_f32_16x16x32_bf16 v[56:59], a[20:23], a[112:115], v[56:59]
    ds_read_b64_tr_b16 a[82:83], v10 offset:16320
    ds_read_b64_tr_b16 a[84:85], v11 offset:14528
    v_mfma_f32_16x16x32_bf16 v[60:63], a[20:23], a[116:119], v[60:63]
    ds_read_b64_tr_b16 a[86:87], v11 offset:16320
    v_mfma_f32_16x16x32_bf16 v[64:67], a[24:27], a[112:115], v[64:67]
    ds_read_b64_tr_b16 a[88:89], v10 offset:14592
    ds_read_b64_tr_b16 a[90:91], v10 offset:16384
    v_mfma_f32_16x16x32_bf16 v[68:71], a[24:27], a[116:119], v[68:71]
    ds_read_b64_tr_b16 a[92:93], v11 offset:14592
    v_mfma_f32_16x16x32_bf16 v[72:75], a[28:31], a[112:115], v[72:75]
    ds_read_b64_tr_b16 a[94:95], v11 offset:16384
    ds_read_b64_tr_b16 a[96:97], v10 offset:14656
    v_mfma_f32_16x16x32_bf16 v[76:79], a[28:31], a[116:119], v[76:79]
    ds_read_b64_tr_b16 a[98:99], v10 offset:16448
    v_mfma_f32_16x16x32_bf16 v[80:83], a[32:35], a[112:115], v[80:83]
    ds_read_b64_tr_b16 a[100:101], v11 offset:14656
    ds_read_b64_tr_b16 a[102:103], v11 offset:16448
    v_mfma_f32_16x16x32_bf16 v[84:87], a[32:35], a[116:119], v[84:87]
    ds_read_b64_tr_b16 a[104:105], v10 offset:14720
    v_mfma_f32_16x16x32_bf16 v[88:91], a[36:39], a[112:115], v[88:91]
    ds_read_b64_tr_b16 a[106:107], v10 offset:16512
    ds_read_b64_tr_b16 a[108:109], v11 offset:14720
    v_mfma_f32_16x16x32_bf16 v[92:95], a[36:39], a[116:119], v[92:95]
    ds_read_b64_tr_b16 a[110:111], v11 offset:16512
    v_mfma_f32_16x16x32_bf16 v[96:99], a[40:43], a[112:115], v[96:99]
    v_mfma_f32_16x16x32_bf16 v[100:103], a[40:43], a[116:119], v[100:103]
    v_mfma_f32_16x16x32_bf16 v[104:107], a[44:47], a[112:115], v[104:107]
    v_mfma_f32_16x16x32_bf16 v[108:111], a[44:47], a[116:119], v[108:111]
    v_mfma_f32_16x16x32_bf16 v[112:115], a[48:51], a[112:115], v[112:115]
    v_mfma_f32_16x16x32_bf16 v[116:119], a[48:51], a[116:119], v[116:119]
    v_mfma_f32_16x16x32_bf16 v[120:123], a[52:55], a[112:115], v[120:123]
    v_mfma_f32_16x16x32_bf16 v[124:127], a[52:55], a[116:119], v[124:127]
    s_waitcnt lgkmcnt(0)
    s_barrier
    v_mfma_f32_16x16x32_bf16 v[16:19], a[56:59], a[120:123], v[16:19]
    ds_read_b128 a[112:115], v14 offset:16384
    ds_read_b128 a[116:119], v14 offset:18432
    v_mfma_f32_16x16x32_bf16 v[20:23], a[56:59], a[124:127], v[20:23]
    ds_read_b64_tr_b16 a[0:1], v10 offset:28672
    v_mfma_f32_16x16x32_bf16 v[24:27], a[60:63], a[120:123], v[24:27]
    ds_read_b64_tr_b16 a[2:3], v10 offset:30464
    ds_read_b64_tr_b16 a[4:5], v11 offset:28672
    v_mfma_f32_16x16x32_bf16 v[28:31], a[60:63], a[124:127], v[28:31]
    ds_read_b64_tr_b16 a[6:7], v11 offset:30464
    v_mfma_f32_16x16x32_bf16 v[32:35], a[64:67], a[120:123], v[32:35]
    ds_read_b64_tr_b16 a[8:9], v10 offset:28736
    ds_read_b64_tr_b16 a[10:11], v10 offset:30528
    v_mfma_f32_16x16x32_bf16 v[36:39], a[64:67], a[124:127], v[36:39]
    ds_read_b64_tr_b16 a[12:13], v11 offset:28736
    v_mfma_f32_16x16x32_bf16 v[40:43], a[68:71], a[120:123], v[40:43]
    ds_read_b64_tr_b16 a[14:15], v11 offset:30528
    ds_read_b64_tr_b16 a[16:17], v10 offset:28800
    v_mfma_f32_16x16x32_bf16 v[44:47], a[68:71], a[124:127], v[44:47]
    ds_read_b64_tr_b16 a[18:19], v10 offset:30592
    v_mfma_f32_16x16x32_bf16 v[48:51], a[72:75], a[120:123], v[48:51]
    ds_read_b64_tr_b16 a[20:21], v11 offset:28800
    ds_read_b64_tr_b16 a[22:23], v11 offset:30592
    v_mfma_f32_16x16x32_bf16 v[52:55], a[72:75], a[124:127], v[52:55]
    ds_read_b64_tr_b16 a[24:25], v10 offset:28864
    v_mfma_f32_16x16x32_bf16 v[56:59], a[76:79], a[120:123], v[56:59]
    ds_read_b64_tr_b16 a[26:27], v10 offset:30656
    ds_read_b64_tr_b16 a[28:29], v11 offset:28864
    v_mfma_f32_16x16x32_bf16 v[60:63], a[76:79], a[124:127], v[60:63]
    ds_read_b64_tr_b16 a[30:31], v11 offset:30656
    v_mfma_f32_16x16x32_bf16 v[64:67], a[80:83], a[120:123], v[64:67]
    ds_read_b64_tr_b16 a[32:33], v10 offset:28928
    ds_read_b64_tr_b16 a[34:35], v10 offset:30720
    v_mfma_f32_16x16x32_bf16 v[68:71], a[80:83], a[124:127], v[68:71]
    ds_read_b64_tr_b16 a[36:37], v11 offset:28928
    v_mfma_f32_16x16x32_bf16 v[72:75], a[84:87], a[120:123], v[72:75]
    ds_read_b64_tr_b16 a[38:39], v11 offset:30720
    ds_read_b64_tr_b16 a[40:41], v10 offset:28992
    v_mfma_f32_16x16x32_bf16 v[76:79], a[84:87], a[124:127], v[76:79]
    ds_read_b64_tr_b16 a[42:43], v10 offset:30784
    v_mfma_f32_16x16x32_bf16 v[80:83], a[88:91], a[120:123], v[80:83]
    ds_read_b64_tr_b16 a[44:45], v11 offset:28992
    ds_read_b64_tr_b16 a[46:47], v11 offset:30784
    v_mfma_f32_16x16x32_bf16 v[84:87], a[88:91], a[124:127], v[84:87]
    ds_read_b64_tr_b16 a[48:49], v10 offset:29056
    v_mfma_f32_16x16x32_bf16 v[88:91], a[92:95], a[120:123], v[88:91]
    ds_read_b64_tr_b16 a[50:51], v10 offset:30848
    ds_read_b64_tr_b16 a[52:53], v11 offset:29056
    v_mfma_f32_16x16x32_bf16 v[92:95], a[92:95], a[124:127], v[92:95]
    ds_read_b64_tr_b16 a[54:55], v11 offset:30848
    v_mfma_f32_16x16x32_bf16 v[96:99], a[96:99], a[120:123], v[96:99]
    v_mfma_f32_16x16x32_bf16 v[100:103], a[96:99], a[124:127], v[100:103]
    v_mfma_f32_16x16x32_bf16 v[104:107], a[100:103], a[120:123], v[104:107]
    v_mfma_f32_16x16x32_bf16 v[108:111], a[100:103], a[124:127], v[108:111]
    v_mfma_f32_16x16x32_bf16 v[112:115], a[104:107], a[120:123], v[112:115]
    v_mfma_f32_16x16x32_bf16 v[116:119], a[104:107], a[124:127], v[116:119]
    v_mfma_f32_16x16x32_bf16 v[120:123], a[108:111], a[120:123], v[120:123]
    v_mfma_f32_16x16x32_bf16 v[124:127], a[108:111], a[124:127], v[124:127]
    s_waitcnt lgkmcnt(0)
    v_mfma_f32_16x16x32_bf16 v[16:19], a[0:3], a[112:115], v[16:19]
    ds_read_b128 a[120:123], v15 offset:16384
    ds_read_b128 a[124:127], v15 offset:18432
    v_mfma_f32_16x16x32_bf16 v[20:23], a[0:3], a[116:119], v[20:23]
    ds_read_b64_tr_b16 a[56:57], v10 offset:43008
    v_mfma_f32_16x16x32_bf16 v[24:27], a[4:7], a[112:115], v[24:27]
    ds_read_b64_tr_b16 a[58:59], v10 offset:44800
    ds_read_b64_tr_b16 a[60:61], v11 offset:43008
    v_mfma_f32_16x16x32_bf16 v[28:31], a[4:7], a[116:119], v[28:31]
    ds_read_b64_tr_b16 a[62:63], v11 offset:44800
    v_mfma_f32_16x16x32_bf16 v[32:35], a[8:11], a[112:115], v[32:35]
    ds_read_b64_tr_b16 a[64:65], v10 offset:43072
    ds_read_b64_tr_b16 a[66:67], v10 offset:44864
    v_mfma_f32_16x16x32_bf16 v[36:39], a[8:11], a[116:119], v[36:39]
    ds_read_b64_tr_b16 a[68:69], v11 offset:43072
    v_mfma_f32_16x16x32_bf16 v[40:43], a[12:15], a[112:115], v[40:43]
    ds_read_b64_tr_b16 a[70:71], v11 offset:44864
    ds_read_b64_tr_b16 a[72:73], v10 offset:43136
    v_mfma_f32_16x16x32_bf16 v[44:47], a[12:15], a[116:119], v[44:47]
    ds_read_b64_tr_b16 a[74:75], v10 offset:44928
    v_mfma_f32_16x16x32_bf16 v[48:51], a[16:19], a[112:115], v[48:51]
    ds_read_b64_tr_b16 a[76:77], v11 offset:43136
    ds_read_b64_tr_b16 a[78:79], v11 offset:44928
    v_mfma_f32_16x16x32_bf16 v[52:55], a[16:19], a[116:119], v[52:55]
    ds_read_b64_tr_b16 a[80:81], v10 offset:43200
    v_mfma_f32_16x16x32_bf16 v[56:59], a[20:23], a[112:115], v[56:59]
    ds_read_b64_tr_b16 a[82:83], v10 offset:44992
    ds_read_b64_tr_b16 a[84:85], v11 offset:43200
    v_mfma_f32_16x16x32_bf16 v[60:63], a[20:23], a[116:119], v[60:63]
    ds_read_b64_tr_b16 a[86:87], v11 offset:44992
    v_mfma_f32_16x16x32_bf16 v[64:67], a[24:27], a[112:115], v[64:67]
    ds_read_b64_tr_b16 a[88:89], v10 offset:43264
    ds_read_b64_tr_b16 a[90:91], v10 offset:45056
    v_mfma_f32_16x16x32_bf16 v[68:71], a[24:27], a[116:119], v[68:71]
    ds_read_b64_tr_b16 a[92:93], v11 offset:43264
    v_mfma_f32_16x16x32_bf16 v[72:75], a[28:31], a[112:115], v[72:75]
    ds_read_b64_tr_b16 a[94:95], v11 offset:45056
    ds_read_b64_tr_b16 a[96:97], v10 offset:43328
    v_mfma_f32_16x16x32_bf16 v[76:79], a[28:31], a[116:119], v[76:79]
    ds_read_b64_tr_b16 a[98:99], v10 offset:45120
    v_mfma_f32_16x16x32_bf16 v[80:83], a[32:35], a[112:115], v[80:83]
    ds_read_b64_tr_b16 a[100:101], v11 offset:43328
    ds_read_b64_tr_b16 a[102:103], v11 offset:45120
    v_mfma_f32_16x16x32_bf16 v[84:87], a[32:35], a[116:119], v[84:87]
    ds_read_b64_tr_b16 a[104:105], v10 offset:43392
    v_mfma_f32_16x16x32_bf16 v[88:91], a[36:39], a[112:115], v[88:91]
    ds_read_b64_tr_b16 a[106:107], v10 offset:45184
    ds_read_b64_tr_b16 a[108:109], v11 offset:43392
    v_mfma_f32_16x16x32_bf16 v[92:95], a[36:39], a[116:119], v[92:95]
    ds_read_b64_tr_b16 a[110:111], v11 offset:45184
    v_mfma_f32_16x16x32_bf16 v[96:99], a[40:43], a[112:115], v[96:99]
    v_mfma_f32_16x16x32_bf16 v[100:103], a[40:43], a[116:119], v[100:103]
    v_mfma_f32_16x16x32_bf16 v[104:107], a[44:47], a[112:115], v[104:107]
    v_mfma_f32_16x16x32_bf16 v[108:111], a[44:47], a[116:119], v[108:111]
    v_mfma_f32_16x16x32_bf16 v[112:115], a[48:51], a[112:115], v[112:115]
    v_mfma_f32_16x16x32_bf16 v[116:119], a[48:51], a[116:119], v[116:119]
    v_mfma_f32_16x16x32_bf16 v[120:123], a[52:55], a[112:115], v[120:123]
    v_mfma_f32_16x16x32_bf16 v[124:127], a[52:55], a[116:119], v[124:127]
    s_waitcnt lgkmcnt(0)
    s_barrier
    v_mfma_f32_16x16x32_bf16 v[16:19], a[56:59], a[120:123], v[16:19]
    ds_read_b128 a[112:115], v14 offset:32768
    ds_read_b128 a[116:119], v14 offset:34816
    v_mfma_f32_16x16x32_bf16 v[20:23], a[56:59], a[124:127], v[20:23]
    ds_read_b64_tr_b16 a[0:1], v12 offset:0
    v_mfma_f32_16x16x32_bf16 v[24:27], a[60:63], a[120:123], v[24:27]
    ds_read_b64_tr_b16 a[2:3], v12 offset:1792
    ds_read_b64_tr_b16 a[4:5], v13 offset:0
    v_mfma_f32_16x16x32_bf16 v[28:31], a[60:63], a[124:127], v[28:31]
    ds_read_b64_tr_b16 a[6:7], v13 offset:1792
    v_mfma_f32_16x16x32_bf16 v[32:35], a[64:67], a[120:123], v[32:35]
    ds_read_b64_tr_b16 a[8:9], v12 offset:64
    ds_read_b64_tr_b16 a[10:11], v12 offset:1856
    v_mfma_f32_16x16x32_bf16 v[36:39], a[64:67], a[124:127], v[36:39]
    ds_read_b64_tr_b16 a[12:13], v13 offset:64
    v_mfma_f32_16x16x32_bf16 v[40:43], a[68:71], a[120:123], v[40:43]
    ds_read_b64_tr_b16 a[14:15], v13 offset:1856
    ds_read_b64_tr_b16 a[16:17], v12 offset:128
    v_mfma_f32_16x16x32_bf16 v[44:47], a[68:71], a[124:127], v[44:47]
    ds_read_b64_tr_b16 a[18:19], v12 offset:1920
    v_mfma_f32_16x16x32_bf16 v[48:51], a[72:75], a[120:123], v[48:51]
    ds_read_b64_tr_b16 a[20:21], v13 offset:128
    ds_read_b64_tr_b16 a[22:23], v13 offset:1920
    v_mfma_f32_16x16x32_bf16 v[52:55], a[72:75], a[124:127], v[52:55]
    ds_read_b64_tr_b16 a[24:25], v12 offset:192
    v_mfma_f32_16x16x32_bf16 v[56:59], a[76:79], a[120:123], v[56:59]
    ds_read_b64_tr_b16 a[26:27], v12 offset:1984
    ds_read_b64_tr_b16 a[28:29], v13 offset:192
    v_mfma_f32_16x16x32_bf16 v[60:63], a[76:79], a[124:127], v[60:63]
    ds_read_b64_tr_b16 a[30:31], v13 offset:1984
    v_mfma_f32_16x16x32_bf16 v[64:67], a[80:83], a[120:123], v[64:67]
    ds_read_b64_tr_b16 a[32:33], v12 offset:256
    ds_read_b64_tr_b16 a[34:35], v12 offset:2048
    v_mfma_f32_16x16x32_bf16 v[68:71], a[80:83], a[124:127], v[68:71]
    ds_read_b64_tr_b16 a[36:37], v13 offset:256
    v_mfma_f32_16x16x32_bf16 v[72:75], a[84:87], a[120:123], v[72:75]
    ds_read_b64_tr_b16 a[38:39], v13 offset:2048
    ds_read_b64_tr_b16 a[40:41], v12 offset:320
    v_mfma_f32_16x16x32_bf16 v[76:79], a[84:87], a[124:127], v[76:79]
    ds_read_b64_tr_b16 a[42:43], v12 offset:2112
    v_mfma_f32_16x16x32_bf16 v[80:83], a[88:91], a[120:123], v[80:83]
    ds_read_b64_tr_b16 a[44:45], v13 offset:320
    ds_read_b64_tr_b16 a[46:47], v13 offset:2112
    v_mfma_f32_16x16x32_bf16 v[84:87], a[88:91], a[124:127], v[84:87]
    ds_read_b64_tr_b16 a[48:49], v12 offset:384
    v_mfma_f32_16x16x32_bf16 v[88:91], a[92:95], a[120:123], v[88:91]
    ds_read_b64_tr_b16 a[50:51], v12 offset:2176
    ds_read_b64_tr_b16 a[52:53], v13 offset:384
    v_mfma_f32_16x16x32_bf16 v[92:95], a[92:95], a[124:127], v[92:95]
    ds_read_b64_tr_b16 a[54:55], v13 offset:2176
    v_mfma_f32_16x16x32_bf16 v[96:99], a[96:99], a[120:123], v[96:99]
    v_mfma_f32_16x16x32_bf16 v[100:103], a[96:99], a[124:127], v[100:103]
    v_mfma_f32_16x16x32_bf16 v[104:107], a[100:103], a[120:123], v[104:107]
    v_mfma_f32_16x16x32_bf16 v[108:111], a[100:103], a[124:127], v[108:111]
    v_mfma_f32_16x16x32_bf16 v[112:115], a[104:107], a[120:123], v[112:115]
    v_mfma_f32_16x16x32_bf16 v[116:119], a[104:107], a[124:127], v[116:119]
    v_mfma_f32_16x16x32_bf16 v[120:123], a[108:111], a[120:123], v[120:123]
    v_mfma_f32_16x16x32_bf16 v[124:127], a[108:111], a[124:127], v[124:127]
    s_waitcnt lgkmcnt(0)
    v_mfma_f32_16x16x32_bf16 v[16:19], a[0:3], a[112:115], v[16:19]
    ds_read_b128 a[120:123], v15 offset:32768
    ds_read_b128 a[124:127], v15 offset:34816
    v_mfma_f32_16x16x32_bf16 v[20:23], a[0:3], a[116:119], v[20:23]
    ds_read_b64_tr_b16 a[56:57], v12 offset:14336
    v_mfma_f32_16x16x32_bf16 v[24:27], a[4:7], a[112:115], v[24:27]
    ds_read_b64_tr_b16 a[58:59], v12 offset:16128
    ds_read_b64_tr_b16 a[60:61], v13 offset:14336
    v_mfma_f32_16x16x32_bf16 v[28:31], a[4:7], a[116:119], v[28:31]
    ds_read_b64_tr_b16 a[62:63], v13 offset:16128
    v_mfma_f32_16x16x32_bf16 v[32:35], a[8:11], a[112:115], v[32:35]
    ds_read_b64_tr_b16 a[64:65], v12 offset:14400
    ds_read_b64_tr_b16 a[66:67], v12 offset:16192
    v_mfma_f32_16x16x32_bf16 v[36:39], a[8:11], a[116:119], v[36:39]
    ds_read_b64_tr_b16 a[68:69], v13 offset:14400
    v_mfma_f32_16x16x32_bf16 v[40:43], a[12:15], a[112:115], v[40:43]
    ds_read_b64_tr_b16 a[70:71], v13 offset:16192
    ds_read_b64_tr_b16 a[72:73], v12 offset:14464
    v_mfma_f32_16x16x32_bf16 v[44:47], a[12:15], a[116:119], v[44:47]
    ds_read_b64_tr_b16 a[74:75], v12 offset:16256
    v_mfma_f32_16x16x32_bf16 v[48:51], a[16:19], a[112:115], v[48:51]
    ds_read_b64_tr_b16 a[76:77], v13 offset:14464
    ds_read_b64_tr_b16 a[78:79], v13 offset:16256
    v_mfma_f32_16x16x32_bf16 v[52:55], a[16:19], a[116:119], v[52:55]
    ds_read_b64_tr_b16 a[80:81], v12 offset:14528
    v_mfma_f32_16x16x32_bf16 v[56:59], a[20:23], a[112:115], v[56:59]
    ds_read_b64_tr_b16 a[82:83], v12 offset:16320
    ds_read_b64_tr_b16 a[84:85], v13 offset:14528
    v_mfma_f32_16x16x32_bf16 v[60:63], a[20:23], a[116:119], v[60:63]
    ds_read_b64_tr_b16 a[86:87], v13 offset:16320
    v_mfma_f32_16x16x32_bf16 v[64:67], a[24:27], a[112:115], v[64:67]
    ds_read_b64_tr_b16 a[88:89], v12 offset:14592
    ds_read_b64_tr_b16 a[90:91], v12 offset:16384
    v_mfma_f32_16x16x32_bf16 v[68:71], a[24:27], a[116:119], v[68:71]
    ds_read_b64_tr_b16 a[92:93], v13 offset:14592
    v_mfma_f32_16x16x32_bf16 v[72:75], a[28:31], a[112:115], v[72:75]
    ds_read_b64_tr_b16 a[94:95], v13 offset:16384
    ds_read_b64_tr_b16 a[96:97], v12 offset:14656
    v_mfma_f32_16x16x32_bf16 v[76:79], a[28:31], a[116:119], v[76:79]
    ds_read_b64_tr_b16 a[98:99], v12 offset:16448
    v_mfma_f32_16x16x32_bf16 v[80:83], a[32:35], a[112:115], v[80:83]
    ds_read_b64_tr_b16 a[100:101], v13 offset:14656
    ds_read_b64_tr_b16 a[102:103], v13 offset:16448
    v_mfma_f32_16x16x32_bf16 v[84:87], a[32:35], a[116:119], v[84:87]
    ds_read_b64_tr_b16 a[104:105], v12 offset:14720
    v_mfma_f32_16x16x32_bf16 v[88:91], a[36:39], a[112:115], v[88:91]
    ds_read_b64_tr_b16 a[106:107], v12 offset:16512
    ds_read_b64_tr_b16 a[108:109], v13 offset:14720
    v_mfma_f32_16x16x32_bf16 v[92:95], a[36:39], a[116:119], v[92:95]
    ds_read_b64_tr_b16 a[110:111], v13 offset:16512
    v_mfma_f32_16x16x32_bf16 v[96:99], a[40:43], a[112:115], v[96:99]
    v_mfma_f32_16x16x32_bf16 v[100:103], a[40:43], a[116:119], v[100:103]
    v_mfma_f32_16x16x32_bf16 v[104:107], a[44:47], a[112:115], v[104:107]
    v_mfma_f32_16x16x32_bf16 v[108:111], a[44:47], a[116:119], v[108:111]
    v_mfma_f32_16x16x32_bf16 v[112:115], a[48:51], a[112:115], v[112:115]
    v_mfma_f32_16x16x32_bf16 v[116:119], a[48:51], a[116:119], v[116:119]
    v_mfma_f32_16x16x32_bf16 v[120:123], a[52:55], a[112:115], v[120:123]
    v_mfma_f32_16x16x32_bf16 v[124:127], a[52:55], a[116:119], v[124:127]
    s_waitcnt lgkmcnt(0)
    s_barrier
    v_mfma_f32_16x16x32_bf16 v[16:19], a[56:59], a[120:123], v[16:19]
    ds_read_b128 a[112:115], v14 offset:0
    ds_read_b128 a[116:119], v14 offset:2048
    v_mfma_f32_16x16x32_bf16 v[20:23], a[56:59], a[124:127], v[20:23]
    ds_read_b64_tr_b16 a[0:1], v10 offset:0
    v_mfma_f32_16x16x32_bf16 v[24:27], a[60:63], a[120:123], v[24:27]
    ds_read_b64_tr_b16 a[2:3], v10 offset:1792
    ds_read_b64_tr_b16 a[4:5], v11 offset:0
    v_mfma_f32_16x16x32_bf16 v[28:31], a[60:63], a[124:127], v[28:31]
    ds_read_b64_tr_b16 a[6:7], v11 offset:1792
    v_mfma_f32_16x16x32_bf16 v[32:35], a[64:67], a[120:123], v[32:35]
    ds_read_b64_tr_b16 a[8:9], v10 offset:64
    ds_read_b64_tr_b16 a[10:11], v10 offset:1856
    v_mfma_f32_16x16x32_bf16 v[36:39], a[64:67], a[124:127], v[36:39]
    ds_read_b64_tr_b16 a[12:13], v11 offset:64
    v_mfma_f32_16x16x32_bf16 v[40:43], a[68:71], a[120:123], v[40:43]
    ds_read_b64_tr_b16 a[14:15], v11 offset:1856
    ds_read_b64_tr_b16 a[16:17], v10 offset:128
    v_mfma_f32_16x16x32_bf16 v[44:47], a[68:71], a[124:127], v[44:47]
    ds_read_b64_tr_b16 a[18:19], v10 offset:1920
    v_mfma_f32_16x16x32_bf16 v[48:51], a[72:75], a[120:123], v[48:51]
    ds_read_b64_tr_b16 a[20:21], v11 offset:128
    ds_read_b64_tr_b16 a[22:23], v11 offset:1920
    v_mfma_f32_16x16x32_bf16 v[52:55], a[72:75], a[124:127], v[52:55]
    ds_read_b64_tr_b16 a[24:25], v10 offset:192
    v_mfma_f32_16x16x32_bf16 v[56:59], a[76:79], a[120:123], v[56:59]
    ds_read_b64_tr_b16 a[26:27], v10 offset:1984
    ds_read_b64_tr_b16 a[28:29], v11 offset:192
    v_mfma_f32_16x16x32_bf16 v[60:63], a[76:79], a[124:127], v[60:63]
    ds_read_b64_tr_b16 a[30:31], v11 offset:1984
    v_mfma_f32_16x16x32_bf16 v[64:67], a[80:83], a[120:123], v[64:67]
    ds_read_b64_tr_b16 a[32:33], v10 offset:256
    ds_read_b64_tr_b16 a[34:35], v10 offset:2048
    v_mfma_f32_16x16x32_bf16 v[68:71], a[80:83], a[124:127], v[68:71]
    ds_read_b64_tr_b16 a[36:37], v11 offset:256
    v_mfma_f32_16x16x32_bf16 v[72:75], a[84:87], a[120:123], v[72:75]
    ds_read_b64_tr_b16 a[38:39], v11 offset:2048
    ds_read_b64_tr_b16 a[40:41], v10 offset:320
    v_mfma_f32_16x16x32_bf16 v[76:79], a[84:87], a[124:127], v[76:79]
    ds_read_b64_tr_b16 a[42:43], v10 offset:2112
    v_mfma_f32_16x16x32_bf16 v[80:83], a[88:91], a[120:123], v[80:83]
    ds_read_b64_tr_b16 a[44:45], v11 offset:320
    ds_read_b64_tr_b16 a[46:47], v11 offset:2112
    v_mfma_f32_16x16x32_bf16 v[84:87], a[88:91], a[124:127], v[84:87]
    ds_read_b64_tr_b16 a[48:49], v10 offset:384
    v_mfma_f32_16x16x32_bf16 v[88:91], a[92:95], a[120:123], v[88:91]
    ds_read_b64_tr_b16 a[50:51], v10 offset:2176
    ds_read_b64_tr_b16 a[52:53], v11 offset:384
    v_mfma_f32_16x16x32_bf16 v[92:95], a[92:95], a[124:127], v[92:95]
    ds_read_b64_tr_b16 a[54:55], v11 offset:2176
    v_mfma_f32_16x16x32_bf16 v[96:99], a[96:99], a[120:123], v[96:99]
    v_mfma_f32_16x16x32_bf16 v[100:103], a[96:99], a[124:127], v[100:103]
    v_mfma_f32_16x16x32_bf16 v[104:107], a[100:103], a[120:123], v[104:107]
    v_mfma_f32_16x16x32_bf16 v[108:111], a[100:103], a[124:127], v[108:111]
    v_mfma_f32_16x16x32_bf16 v[112:115], a[104:107], a[120:123], v[112:115]
    v_mfma_f32_16x16x32_bf16 v[116:119], a[104:107], a[124:127], v[116:119]
    v_mfma_f32_16x16x32_bf16 v[120:123], a[108:111], a[120:123], v[120:123]
    s_add_u32 s39, s39, 1
    s_cmp_lt_u32 s39, 5
    v_mfma_f32_16x16x32_bf16 v[124:127], a[108:111], a[124:127], v[124:127]
    s_cbranch_scc1 L1_loop
    s_waitcnt lgkmcnt(0)
    v_mfma_f32_16x16x32_bf16 v[16:19], a[0:3], a[112:115], v[16:19]
    ds_read_b128 a[120:123], v15 offset:0
    ds_read_b128 a[124:127], v15 offset:2048
    v_mfma_f32_16x16x32_bf16 v[20:23], a[0:3], a[116:119], v[20:23]
    ds_read_b64_tr_b16 a[56:57], v10 offset:14336
    v_mfma_f32_16x16x32_bf16 v[24:27], a[4:7], a[112:115], v[24:27]
    ds_read_b64_tr_b16 a[58:59], v10 offset:16128
    ds_read_b64_tr_b16 a[60:61], v11 offset:14336
    v_mfma_f32_16x16x32_bf16 v[28:31], a[4:7], a[116:119], v[28:31]
    ds_read_b64_tr_b16 a[62:63], v11 offset:16128
    v_mfma_f32_16x16x32_bf16 v[32:35], a[8:11], a[112:115], v[32:35]
    ds_read_b64_tr_b16 a[64:65], v10 offset:14400
    ds_read_b64_tr_b16 a[66:67], v10 offset:16192
    v_mfma_f32_16x16x32_bf16 v[36:39], a[8:11], a[116:119], v[36:39]
    ds_read_b64_tr_b16 a[68:69], v11 offset:14400
    v_mfma_f32_16x16x32_bf16 v[40:43], a[12:15], a[112:115], v[40:43]
    ds_read_b64_tr_b16 a[70:71], v11 offset:16192
    ds_read_b64_tr_b16 a[72:73], v10 offset:14464
    v_mfma_f32_16x16x32_bf16 v[44:47], a[12:15], a[116:119], v[44:47]
    ds_read_b64_tr_b16 a[74:75], v10 offset:16256
    v_mfma_f32_16x16x32_bf16 v[48:51], a[16:19], a[112:115], v[48:51]
    ds_read_b64_tr_b16 a[76:77], v11 offset:14464
    ds_read_b64_tr_b16 a[78:79], v11 offset:16256
    v_mfma_f32_16x16x32_bf16 v[52:55], a[16:19], a[116:119], v[52:55]
    ds_read_b64_tr_b16 a[80:81], v10 offset:14528
    v_mfma_f32_16x16x32_bf16 v[56:59], a[20:23], a[112:115], v[56:59]
    ds_read_b64_tr_b16 a[82:83], v10 offset:16320
    ds_read_b64_tr_b16 a[84:85], v11 offset:14528
    v_mfma_f32_16x16x32_bf16 v[60:63], a[20:23], a[116:119], v[60:63]
    ds_read_b64_tr_b16 a[86:87], v11 offset:16320
    v_mfma_f32_16x16x32_bf16 v[64:67], a[24:27], a[112:115], v[64:67]
    ds_read_b64_tr_b16 a[88:89], v10 offset:14592
    ds_read_b64_tr_b16 a[90:91], v10 offset:16384
    v_mfma_f32_16x16x32_bf16 v[68:71], a[24:27], a[116:119], v[68:71]
    ds_read_b64_tr_b16 a[92:93], v11 offset:14592
    v_mfma_f32_16x16x32_bf16 v[72:75], a[28:31], a[112:115], v[72:75]
    ds_read_b64_tr_b16 a[94:95], v11 offset:16384
    ds_read_b64_tr_b16 a[96:97], v10 offset:14656
    v_mfma_f32_16x16x32_bf16 v[76:79], a[28:31], a[116:119], v[76:79]
    ds_read_b64_tr_b16 a[98:99], v10 offset:16448
    v_mfma_f32_16x16x32_bf16 v[80:83], a[32:35], a[112:115], v[80:83]
    ds_read_b64_tr_b16 a[100:101], v11 offset:14656
    ds_read_b64_tr_b16 a[102:103], v11 offset:16448
    v_mfma_f32_16x16x32_bf16 v[84:87], a[32:35], a[116:119], v[84:87]
    ds_read_b64_tr_b16 a[104:105], v10 offset:14720
    v_mfma_f32_16x16x32_bf16 v[88:91], a[36:39], a[112:115], v[88:91]
    ds_read_b64_tr_b16 a[106:107], v10 offset:16512
    ds_read_b64_tr_b16 a[108:109], v11 offset:14720
    v_mfma_f32_16x16x32_bf16 v[92:95], a[36:39], a[116:119], v[92:95]
    ds_read_b64_tr_b16 a[110:111], v11 offset:16512
    v_mfma_f32_16x16x32_bf16 v[96:99], a[40:43], a[112:115], v[96:99]
    v_mfma_f32_16x16x32_bf16 v[100:103], a[40:43], a[116:119], v[100:103]
    v_mfma_f32_16x16x32_bf16 v[104:107], a[44:47], a[112:115], v[104:107]
    v_mfma_f32_16x16x32_bf16 v[108:111], a[44:47], a[116:119], v[108:111]
    v_mfma_f32_16x16x32_bf16 v[112:115], a[48:51], a[112:115], v[112:115]
    buffer_load_dwordx2 v[4:5], v7, s[56:59], 0 offen sc1
    v_lshlrev_b32 v2, 2, v0
    buffer_load_dword v2, s[28:31], 0 offen lds
    v_mfma_f32_16x16x32_bf16 v[116:119], a[48:51], a[116:119], v[116:119]
    v_mfma_f32_16x16x32_bf16 v[120:123], a[52:55], a[112:115], v[120:123]
    v_mfma_f32_16x16x32_bf16 v[124:127], a[52:55], a[116:119], v[124:127]
    s_waitcnt lgkmcnt(0)
    v_mfma_f32_16x16x32_bf16 v[16:19], a[56:59], a[120:123], v[16:19]
    v_mfma_f32_16x16x32_bf16 v[20:23], a[56:59], a[124:127], v[20:23]
    v_mfma_f32_16x16x32_bf16 v[24:27], a[60:63], a[120:123], v[24:27]
    v_mfma_f32_16x16x32_bf16 v[28:31], a[60:63], a[124:127], v[28:31]
    v_mfma_f32_16x16x32_bf16 v[32:35], a[64:67], a[120:123], v[32:35]
    v_mfma_f32_16x16x32_bf16 v[36:39], a[64:67], a[124:127], v[36:39]
    v_mfma_f32_16x16x32_bf16 v[40:43], a[68:71], a[120:123], v[40:43]
    v_mfma_f32_16x16x32_bf16 v[44:47], a[68:71], a[124:127], v[44:47]
    v_mfma_f32_16x16x32_bf16 v[48:51], a[72:75], a[120:123], v[48:51]
    v_mfma_f32_16x16x32_bf16 v[52:55], a[72:75], a[124:127], v[52:55]
    v_mfma_f32_16x16x32_bf16 v[56:59], a[76:79], a[120:123], v[56:59]
    v_mfma_f32_16x16x32_bf16 v[60:63], a[76:79], a[124:127], v[60:63]
    v_mfma_f32_16x16x32_bf16 v[64:67], a[80:83], a[120:123], v[64:67]
    v_mfma_f32_16x16x32_bf16 v[68:71], a[80:83], a[124:127], v[68:71]
    v_mfma_f32_16x16x32_bf16 v[72:75], a[84:87], a[120:123], v[72:75]
    v_mfma_f32_16x16x32_bf16 v[76:79], a[84:87], a[124:127], v[76:79]
    v_mfma_f32_16x16x32_bf16 v[80:83], a[88:91], a[120:123], v[80:83]
    v_mfma_f32_16x16x32_bf16 v[84:87], a[88:91], a[124:127], v[84:87]
    v_mfma_f32_16x16x32_bf16 v[88:91], a[92:95], a[120:123], v[88:91]
    v_mfma_f32_16x16x32_bf16 v[92:95], a[92:95], a[124:127], v[92:95]
    v_mfma_f32_16x16x32_bf16 v[96:99], a[96:99], a[120:123], v[96:99]
    v_mfma_f32_16x16x32_bf16 v[100:103], a[96:99], a[124:127], v[100:103]
    v_mfma_f32_16x16x32_bf16 v[104:107], a[100:103], a[120:123], v[104:107]
    v_mfma_f32_16x16x32_bf16 v[108:111], a[100:103], a[124:127], v[108:111]
    v_mfma_f32_16x16x32_bf16 v[112:115], a[104:107], a[120:123], v[112:115]
    v_mfma_f32_16x16x32_bf16 v[116:119], a[104:107], a[124:127], v[116:119]
    v_mfma_f32_16x16x32_bf16 v[120:123], a[108:111], a[120:123], v[120:123]
    v_mfma_f32_16x16x32_bf16 v[124:127], a[108:111], a[124:127], v[124:127]
    v_max_f32 v16, 0, v16
    v_max_f32 v17, 0, v17
    v_max_f32 v18, 0, v18
    v_max_f32 v19, 0, v19
    v_pk_mul_f32 v[16:17], v[16:17], v[16:17]
    v_pk_mul_f32 v[18:19], v[18:19], v[18:19]
    v_cvt_pk_bf16_f32 v16, v16, v17
    v_cvt_pk_bf16_f32 v17, v18, v19
    v_max_f32 v24, 0, v24
    v_max_f32 v25, 0, v25
    v_max_f32 v26, 0, v26
    v_max_f32 v27, 0, v27
    v_pk_mul_f32 v[24:25], v[24:25], v[24:25]
    v_pk_mul_f32 v[26:27], v[26:27], v[26:27]
    v_cvt_pk_bf16_f32 v18, v24, v25
    v_cvt_pk_bf16_f32 v19, v26, v27
    buffer_store_dwordx4 v[16:19], v1, s[48:51], s99 offen offset:0 sc1
    v_max_f32 v20, 0, v20
    v_max_f32 v21, 0, v21
    v_max_f32 v22, 0, v22
    v_max_f32 v23, 0, v23
    v_pk_mul_f32 v[20:21], v[20:21], v[20:21]
    v_pk_mul_f32 v[22:23], v[22:23], v[22:23]
    v_cvt_pk_bf16_f32 v20, v20, v21
    v_cvt_pk_bf16_f32 v21, v22, v23
    v_max_f32 v28, 0, v28
    v_max_f32 v29, 0, v29
    v_max_f32 v30, 0, v30
    v_max_f32 v31, 0, v31
    v_pk_mul_f32 v[28:29], v[28:29], v[28:29]
    v_pk_mul_f32 v[30:31], v[30:31], v[30:31]
    v_cvt_pk_bf16_f32 v22, v28, v29
    v_cvt_pk_bf16_f32 v23, v30, v31
    buffer_store_dwordx4 v[20:23], v1, s[48:51], s99 offen offset:1024 sc1
    s_add_u32 s99, s99, 8192
    v_max_f32 v32, 0, v32
    v_max_f32 v33, 0, v33
    v_max_f32 v34, 0, v34
    v_max_f32 v35, 0, v35
    v_pk_mul_f32 v[32:33], v[32:33], v[32:33]
    v_pk_mul_f32 v[34:35], v[34:35], v[34:35]
    v_cvt_pk_bf16_f32 v32, v32, v33
    v_cvt_pk_bf16_f32 v33, v34, v35
    v_max_f32 v40, 0, v40
    v_max_f32 v41, 0, v41
    v_max_f32 v42, 0, v42
    v_max_f32 v43, 0, v43
    v_pk_mul_f32 v[40:41], v[40:41], v[40:41]
    v_pk_mul_f32 v[42:43], v[42:43], v[42:43]
    v_cvt_pk_bf16_f32 v34, v40, v41
    v_cvt_pk_bf16_f32 v35, v42, v43
    buffer_store_dwordx4 v[32:35], v1, s[48:51], s99 offen offset:0 sc1
    v_max_f32 v36, 0, v36
    v_max_f32 v37, 0, v37
    v_max_f32 v38, 0, v38
    v_max_f32 v39, 0, v39
    v_pk_mul_f32 v[36:37], v[36:37], v[36:37]
    v_pk_mul_f32 v[38:39], v[38:39], v[38:39]
    v_cvt_pk_bf16_f32 v36, v36, v37
    v_cvt_pk_bf16_f32 v37, v38, v39
    v_max_f32 v44, 0, v44
    v_max_f32 v45, 0, v45
    v_max_f32 v46, 0, v46
    v_max_f32 v47, 0, v47
    v_pk_mul_f32 v[44:45], v[44:45], v[44:45]
    v_pk_mul_f32 v[46:47], v[46:47], v[46:47]
    v_cvt_pk_bf16_f32 v38, v44, v45
    v_cvt_pk_bf16_f32 v39, v46, v47
    buffer_store_dwordx4 v[36:39], v1, s[48:51], s99 offen offset:1024 sc1
    s_add_u32 s99, s99, 8192
    v_max_f32 v48, 0, v48
    v_max_f32 v49, 0, v49
    v_max_f32 v50, 0, v50
    v_max_f32 v51, 0, v51
    v_pk_mul_f32 v[48:49], v[48:49], v[48:49]
    v_pk_mul_f32 v[50:51], v[50:51], v[50:51]
    v_cvt_pk_bf16_f32 v48, v48, v49
    v_cvt_pk_bf16_f32 v49, v50, v51
    v_max_f32 v56, 0, v56
    v_max_f32 v57, 0, v57
    v_max_f32 v58, 0, v58
    v_max_f32 v59, 0, v59
    v_pk_mul_f32 v[56:57], v[56:57], v[56:57]
    v_pk_mul_f32 v[58:59], v[58:59], v[58:59]
    v_cvt_pk_bf16_f32 v50, v56, v57
    v_cvt_pk_bf16_f32 v51, v58, v59
    buffer_store_dwordx4 v[48:51], v1, s[48:51], s99 offen offset:0 sc1
    v_max_f32 v52, 0, v52
    v_max_f32 v53, 0, v53
    v_max_f32 v54, 0, v54
    v_max_f32 v55, 0, v55
    v_pk_mul_f32 v[52:53], v[52:53], v[52:53]
    v_pk_mul_f32 v[54:55], v[54:55], v[54:55]
    v_cvt_pk_bf16_f32 v52, v52, v53
    v_cvt_pk_bf16_f32 v53, v54, v55
    v_max_f32 v60, 0, v60
    v_max_f32 v61, 0, v61
    v_max_f32 v62, 0, v62
    v_max_f32 v63, 0, v63
    v_pk_mul_f32 v[60:61], v[60:61], v[60:61]
    v_pk_mul_f32 v[62:63], v[62:63], v[62:63]
    v_cvt_pk_bf16_f32 v54, v60, v61
    v_cvt_pk_bf16_f32 v55, v62, v63
    buffer_store_dwordx4 v[52:55], v1, s[48:51], s99 offen offset:1024 sc1
    s_add_u32 s99, s99, 8192
    v_max_f32 v64, 0, v64
    v_max_f32 v65, 0, v65
    v_max_f32 v66, 0, v66
    v_max_f32 v67, 0, v67
    v_pk_mul_f32 v[64:65], v[64:65], v[64:65]
    v_pk_mul_f32 v[66:67], v[66:67], v[66:67]
    v_cvt_pk_bf16_f32 v64, v64, v65
    v_cvt_pk_bf16_f32 v65, v66, v67
    v_max_f32 v72, 0, v72
    v_max_f32 v73, 0, v73
    v_max_f32 v74, 0, v74
    v_max_f32 v75, 0, v75
    v_pk_mul_f32 v[72:73], v[72:73], v[72:73]
    v_pk_mul_f32 v[74:75], v[74:75], v[74:75]
    v_cvt_pk_bf16_f32 v66, v72, v73
    v_cvt_pk_bf16_f32 v67, v74, v75
    buffer_store_dwordx4 v[64:67], v1, s[48:51], s99 offen offset:0 sc1
    v_max_f32 v68, 0, v68
    v_max_f32 v69, 0, v69
    v_max_f32 v70, 0, v70
    v_max_f32 v71, 0, v71
    v_pk_mul_f32 v[68:69], v[68:69], v[68:69]
    v_pk_mul_f32 v[70:71], v[70:71], v[70:71]
    v_cvt_pk_bf16_f32 v68, v68, v69
    v_cvt_pk_bf16_f32 v69, v70, v71
    v_max_f32 v76, 0, v76
    v_max_f32 v77, 0, v77
    v_max_f32 v78, 0, v78
    v_max_f32 v79, 0, v79
    v_pk_mul_f32 v[76:77], v[76:77], v[76:77]
    v_pk_mul_f32 v[78:79], v[78:79], v[78:79]
    v_cvt_pk_bf16_f32 v70, v76, v77
    v_cvt_pk_bf16_f32 v71, v78, v79
    buffer_store_dwordx4 v[68:71], v1, s[48:51], s99 offen offset:1024 sc1
    s_add_u32 s99, s99, 8192
    v_max_f32 v80, 0, v80
    v_max_f32 v81, 0, v81
    v_max_f32 v82, 0, v82
    v_max_f32 v83, 0, v83
    v_pk_mul_f32 v[80:81], v[80:81], v[80:81]
    v_pk_mul_f32 v[82:83], v[82:83], v[82:83]
    v_cvt_pk_bf16_f32 v80, v80, v81
    v_cvt_pk_bf16_f32 v81, v82, v83
    v_max_f32 v88, 0, v88
    v_max_f32 v89, 0, v89
    v_max_f32 v90, 0, v90
    v_max_f32 v91, 0, v91
    v_pk_mul_f32 v[88:89], v[88:89], v[88:89]
    v_pk_mul_f32 v[90:91], v[90:91], v[90:91]
    v_cvt_pk_bf16_f32 v82, v88, v89
    v_cvt_pk_bf16_f32 v83, v90, v91
    buffer_store_dwordx4 v[80:83], v1, s[48:51], s99 offen offset:0 sc1
    v_max_f32 v84, 0, v84
    v_max_f32 v85, 0, v85
    v_max_f32 v86, 0, v86
    v_max_f32 v87, 0, v87
    v_pk_mul_f32 v[84:85], v[84:85], v[84:85]
    v_pk_mul_f32 v[86:87], v[86:87], v[86:87]
    v_cvt_pk_bf16_f32 v84, v84, v85
    v_cvt_pk_bf16_f32 v85, v86, v87
    v_max_f32 v92, 0, v92
    v_max_f32 v93, 0, v93
    v_max_f32 v94, 0, v94
    v_max_f32 v95, 0, v95
    v_pk_mul_f32 v[92:93], v[92:93], v[92:93]
    v_pk_mul_f32 v[94:95], v[94:95], v[94:95]
    v_cvt_pk_bf16_f32 v86, v92, v93
    v_cvt_pk_bf16_f32 v87, v94, v95
    buffer_store_dwordx4 v[84:87], v1, s[48:51], s99 offen offset:1024 sc1
    s_add_u32 s99, s99, 8192
    v_lshrrev_b32 v2, 2, v0
    v_and_b32 v8, 7, v2
    s_lshl_b32 s16, s14, 2
    v_xor_b32 v8, s16, v8
    v_lshlrev_b32 v2, 8, v2
    v_and_b32 v9, 3, v0
    v_lshl_add_u32 v2, v9, 3, v2
    v_add_u32 v2, 73728, v2
    v_xor_b32 v9, 0, v8
    v_lshl_add_u32 v88, v9, 5, v2
    v_xor_b32 v9, 1, v8
    v_lshl_add_u32 v89, v9, 5, v2
    v_xor_b32 v9, 2, v8
    v_lshl_add_u32 v90, v9, 5, v2
    v_xor_b32 v9, 3, v8
    v_lshl_add_u32 v91, v9, 5, v2
    v_xor_b32 v9, 4, v8
    v_lshl_add_u32 v92, v9, 5, v2
    v_xor_b32 v9, 5, v8
    v_lshl_add_u32 v93, v9, 5, v2
    v_xor_b32 v9, 6, v8
    v_lshl_add_u32 v94, v9, 5, v2
    v_xor_b32 v9, 7, v8
    v_lshl_add_u32 v95, v9, 5, v2
    v_max_f32 v96, 0, v96
    v_max_f32 v97, 0, v97
    v_max_f32 v98, 0, v98
    v_max_f32 v99, 0, v99
    v_pk_mul_f32 v[96:97], v[96:97], v[96:97]
    v_pk_mul_f32 v[98:99], v[98:99], v[98:99]
    v_cvt_pk_bf16_f32 v96, v96, v97
    v_cvt_pk_bf16_f32 v97, v98, v99
    v_max_f32 v104, 0, v104
    v_max_f32 v105, 0, v105
    v_max_f32 v106, 0, v106
    v_max_f32 v107, 0, v107
    v_pk_mul_f32 v[104:105], v[104:105], v[104:105]
    v_pk_mul_f32 v[106:107], v[106:107], v[106:107]
    v_cvt_pk_bf16_f32 v98, v104, v105
    v_cvt_pk_bf16_f32 v99, v106, v107
    buffer_store_dwordx4 v[96:99], v1, s[48:51], s99 offen offset:0 sc1
    v_max_f32 v100, 0, v100
    v_max_f32 v101, 0, v101
    v_max_f32 v102, 0, v102
    v_max_f32 v103, 0, v103
    v_pk_mul_f32 v[100:101], v[100:101], v[100:101]
    v_pk_mul_f32 v[102:103], v[102:103], v[102:103]
    v_cvt_pk_bf16_f32 v100, v100, v101
    v_cvt_pk_bf16_f32 v101, v102, v103
    v_max_f32 v108, 0, v108
    v_max_f32 v109, 0, v109
    v_max_f32 v110, 0, v110
    v_max_f32 v111, 0, v111
    v_pk_mul_f32 v[108:109], v[108:109], v[108:109]
    v_pk_mul_f32 v[110:111], v[110:111], v[110:111]
    v_cvt_pk_bf16_f32 v102, v108, v109
    v_cvt_pk_bf16_f32 v103, v110, v111
    buffer_store_dwordx4 v[100:103], v1, s[48:51], s99 offen offset:1024 sc1
    s_add_u32 s99, s99, 8192
    s_waitcnt vmcnt(12)
    s_barrier
    ds_read_b64 v[104:105], v6 offset:0
    ds_read_b64 v[106:107], v6 offset:32
    ds_read_b64 v[108:109], v6 offset:64
    ds_read_b64 v[110:111], v6 offset:96
    ds_read_b64_tr_b16 a[0:1], v88 offset:0
    ds_read_b64_tr_b16 a[2:3], v88 offset:4096
    ds_read_b64_tr_b16 a[4:5], v89 offset:0
    ds_read_b64_tr_b16 a[6:7], v89 offset:4096
    ds_read_b64_tr_b16 a[8:9], v90 offset:0
    ds_read_b64_tr_b16 a[10:11], v90 offset:4096
    ds_read_b64_tr_b16 a[12:13], v91 offset:0
    ds_read_b64_tr_b16 a[14:15], v91 offset:4096
    ds_read_b64_tr_b16 a[16:17], v92 offset:0
    ds_read_b64_tr_b16 a[18:19], v92 offset:4096
    ds_read_b64_tr_b16 a[20:21], v93 offset:0
    ds_read_b64_tr_b16 a[22:23], v93 offset:4096
    ds_read_b64_tr_b16 a[24:25], v94 offset:0
    ds_read_b64_tr_b16 a[26:27], v94 offset:4096
    ds_read_b64_tr_b16 a[28:29], v95 offset:0
    ds_read_b64_tr_b16 a[30:31], v95 offset:4096
    v_max_f32 v112, 0, v112
    v_max_f32 v113, 0, v113
    v_max_f32 v114, 0, v114
    v_max_f32 v115, 0, v115
    v_pk_mul_f32 v[112:113], v[112:113], v[112:113]
    v_pk_mul_f32 v[114:115], v[114:115], v[114:115]
    v_cvt_pk_bf16_f32 v112, v112, v113
    v_cvt_pk_bf16_f32 v113, v114, v115
    v_max_f32 v120, 0, v120
    v_max_f32 v121, 0, v121
    v_max_f32 v122, 0, v122
    v_max_f32 v123, 0, v123
    v_pk_mul_f32 v[120:121], v[120:121], v[120:121]
    v_pk_mul_f32 v[122:123], v[122:123], v[122:123]
    v_cvt_pk_bf16_f32 v114, v120, v121
    v_cvt_pk_bf16_f32 v115, v122, v123
    buffer_store_dwordx4 v[112:115], v1, s[48:51], s99 offen offset:0 sc1
    v_max_f32 v116, 0, v116
    v_max_f32 v117, 0, v117
    v_max_f32 v118, 0, v118
    v_max_f32 v119, 0, v119
    v_pk_mul_f32 v[116:117], v[116:117], v[116:117]
    v_pk_mul_f32 v[118:119], v[118:119], v[118:119]
    v_cvt_pk_bf16_f32 v116, v116, v117
    v_cvt_pk_bf16_f32 v117, v118, v119
    v_max_f32 v124, 0, v124
    v_max_f32 v125, 0, v125
    v_max_f32 v126, 0, v126
    v_max_f32 v127, 0, v127
    v_pk_mul_f32 v[124:125], v[124:125], v[124:125]
    v_pk_mul_f32 v[126:127], v[126:127], v[126:127]
    v_cvt_pk_bf16_f32 v118, v124, v125
    v_cvt_pk_bf16_f32 v119, v126, v127
    buffer_store_dwordx4 v[116:119], v1, s[48:51], s99 offen offset:1024 sc1
    s_add_u32 s99, s99, 8192
    v_and_b32 v11, 7, v0
    v_lshlrev_b32 v11, 3, v11
    s_waitcnt lgkmcnt(0)
    v_lshlrev_b32 v24, 16, v104
    v_and_b32 v25, 0xffff0000, v104
    v_lshlrev_b32 v26, 16, v105
    v_and_b32 v27, 0xffff0000, v105
    v_lshlrev_b32 v28, 16, v104
    v_and_b32 v29, 0xffff0000, v104
    v_lshlrev_b32 v30, 16, v105
    v_and_b32 v31, 0xffff0000, v105
    v_lshlrev_b32 v40, 16, v106
    v_and_b32 v41, 0xffff0000, v106
    v_lshlrev_b32 v42, 16, v107
    v_and_b32 v43, 0xffff0000, v107
    v_lshlrev_b32 v44, 16, v106
    v_and_b32 v45, 0xffff0000, v106
    v_lshlrev_b32 v46, 16, v107
    v_and_b32 v47, 0xffff0000, v107
    v_lshlrev_b32 v56, 16, v108
    v_and_b32 v57, 0xffff0000, v108
    v_lshlrev_b32 v58, 16, v109
    v_and_b32 v59, 0xffff0000, v109
    v_lshlrev_b32 v60, 16, v108
    v_and_b32 v61, 0xffff0000, v108
    v_lshlrev_b32 v62, 16, v109
    v_and_b32 v63, 0xffff0000, v109
    v_lshlrev_b32 v72, 16, v110
    v_and_b32 v73, 0xffff0000, v110
    v_lshlrev_b32 v74, 16, v111
    v_and_b32 v75, 0xffff0000, v111
    v_lshlrev_b32 v76, 16, v110
    v_and_b32 v77, 0xffff0000, v110
    v_lshlrev_b32 v78, 16, v111
    v_and_b32 v79, 0xffff0000, v111
    v_readfirstlane_b32 s93, v5
    s_mov_b32 s39, 0
    s_cmp_lg_u32 s93, 0
    s_cbranch_scc1 L_nok
L_nsp:
    s_sleep 2
    buffer_load_dwordx2 v[4:5], v7, s[56:59], 0 offen sc1
    s_add_u32 s39, s39, 1
    s_waitcnt vmcnt(0)
    v_readfirstlane_b32 s93, v5
    s_lshr_b32 s16, s39, 19
    s_or_b32 s16, s16, s93
    s_cmp_eq_u32 s16, 0
    s_cbranch_scc1 L_nsp
L_nok:
    s_waitcnt lgkmcnt(0)
    v_mfma_f32_16x16x32_bf16 v[24:27], a[0:3], v[16:19], v[24:27]
    ds_read_b64_tr_b16 a[32:33], v88 offset:8192
    ds_read_b64_tr_b16 a[34:35], v88 offset:12288
    v_mfma_f32_16x16x32_bf16 v[28:31], a[0:3], v[20:23], v[28:31]
    ds_read_b64_tr_b16 a[36:37], v89 offset:8192
    v_mfma_f32_16x16x32_bf16 v[40:43], a[4:7], v[16:19], v[40:43]
    ds_read_b64_tr_b16 a[38:39], v89 offset:12288
    ds_read_b64_tr_b16 a[40:41], v90 offset:8192
    v_mfma_f32_16x16x32_bf16 v[44:47], a[4:7], v[20:23], v[44:47]
    ds_read_b64_tr_b16 a[42:43], v90 offset:12288
    v_mfma_f32_16x16x32_bf16 v[56:59], a[8:11], v[16:19], v[56:59]
    ds_read_b64_tr_b16 a[44:45], v91 offset:8192
    ds_read_b64_tr_b16 a[46:47], v91 offset:12288
    v_mfma_f32_16x16x32_bf16 v[60:63], a[8:11], v[20:23], v[60:63]
    ds_read_b64_tr_b16 a[48:49], v92 offset:8192
    v_mfma_f32_16x16x32_bf16 v[72:75], a[12:15], v[16:19], v[72:75]
    ds_read_b64_tr_b16 a[50:51], v92 offset:12288
    ds_read_b64_tr_b16 a[52:53], v93 offset:8192
    v_mfma_f32_16x16x32_bf16 v[76:79], a[12:15], v[20:23], v[76:79]
    ds_read_b64_tr_b16 a[54:55], v93 offset:12288
    v_mfma_f32_16x16x32_bf16 a[96:99], a[16:19], v[16:19], 0
    ds_read_b64_tr_b16 a[56:57], v94 offset:8192
    ds_read_b64_tr_b16 a[58:59], v94 offset:12288
    v_mfma_f32_16x16x32_bf16 a[100:103], a[16:19], v[20:23], 0
    ds_read_b64_tr_b16 a[60:61], v95 offset:8192
    v_mfma_f32_16x16x32_bf16 a[104:107], a[20:23], v[16:19], 0
    ds_read_b64_tr_b16 a[62:63], v95 offset:12288
    v_mfma_f32_16x16x32_bf16 a[108:111], a[20:23], v[20:23], 0
    v_mfma_f32_16x16x32_bf16 a[112:115], a[24:27], v[16:19], 0
    v_mfma_f32_16x16x32_bf16 a[116:119], a[24:27], v[20:23], 0
    v_mfma_f32_16x16x32_bf16 a[120:123], a[28:31], v[16:19], 0
    v_mfma_f32_16x16x32_bf16 a[124:127], a[28:31], v[20:23], 0
    s_waitcnt lgkmcnt(0)
    s_barrier
    v_mfma_f32_16x16x32_bf16 v[24:27], a[32:35], v[32:35], v[24:27]
    ds_read_b64_tr_b16 a[0:1], v88 offset:16384
    ds_read_b64_tr_b16 a[2:3], v88 offset:20480
    v_mfma_f32_16x16x32_bf16 v[28:31], a[32:35], v[36:39], v[28:31]
    ds_read_b64_tr_b16 a[4:5], v89 offset:16384
    v_mfma_f32_16x16x32_bf16 v[40:43], a[36:39], v[32:35], v[40:43]
    ds_read_b64_tr_b16 a[6:7], v89 offset:20480
    ds_read_b64_tr_b16 a[8:9], v90 offset:16384
    v_mfma_f32_16x16x32_bf16 v[44:47], a[36:39], v[36:39], v[44:47]
    ds_read_b64_tr_b16 a[10:11], v90 offset:20480
    v_mfma_f32_16x16x32_bf16 v[56:59], a[40:43], v[32:35], v[56:59]
    ds_read_b64_tr_b16 a[12:13], v91 offset:16384
    ds_read_b64_tr_b16 a[14:15], v91 offset:20480
    v_mfma_f32_16x16x32_bf16 v[60:63], a[40:43], v[36:39], v[60:63]
    ds_read_b64_tr_b16 a[16:17], v92 offset:16384
    v_mfma_f32_16x16x32_bf16 v[72:75], a[44:47], v[32:35], v[72:75]
    ds_read_b64_tr_b16 a[18:19], v92 offset:20480
    ds_read_b64_tr_b16 a[20:21], v93 offset:16384
    v_mfma_f32_16x16x32_bf16 v[76:79], a[44:47], v[36:39], v[76:79]
    ds_read_b64_tr_b16 a[22:23], v93 offset:20480
    v_mfma_f32_16x16x32_bf16 a[96:99], a[48:51], v[32:35], a[96:99]
    ds_read_b64_tr_b16 a[24:25], v94 offset:16384
    ds_read_b64_tr_b16 a[26:27], v94 offset:20480
    v_mfma_f32_16x16x32_bf16 a[100:103], a[48:51], v[36:39], a[100:103]
    ds_read_b64_tr_b16 a[28:29], v95 offset:16384
    v_mfma_f32_16x16x32_bf16 a[104:107], a[52:55], v[32:35], a[104:107]
    ds_read_b64_tr_b16 a[30:31], v95 offset:20480
    v_mfma_f32_16x16x32_bf16 a[108:111], a[52:55], v[36:39], a[108:111]
    v_mfma_f32_16x16x32_bf16 a[112:115], a[56:59], v[32:35], a[112:115]
    v_mfma_f32_16x16x32_bf16 a[116:119], a[56:59], v[36:39], a[116:119]
    v_mfma_f32_16x16x32_bf16 a[120:123], a[60:63], v[32:35], a[120:123]
    v_mfma_f32_16x16x32_bf16 a[124:127], a[60:63], v[36:39], a[124:127]
    s_waitcnt vmcnt(0) lgkmcnt(0)
    buffer_store_dwordx2 v[4:5], v7, s[48:51], s86 offen sc1
    v_mfma_f32_16x16x32_bf16 v[24:27], a[0:3], v[48:51], v[24:27]
    ds_read_b64_tr_b16 a[32:33], v88 offset:24576
    ds_read_b64_tr_b16 a[34:35], v88 offset:28672
    v_mfma_f32_16x16x32_bf16 v[28:31], a[0:3], v[52:55], v[28:31]
    ds_read_b64_tr_b16 a[36:37], v89 offset:24576
    v_mfma_f32_16x16x32_bf16 v[40:43], a[4:7], v[48:51], v[40:43]
    ds_read_b64_tr_b16 a[38:39], v89 offset:28672
    ds_read_b64_tr_b16 a[40:41], v90 offset:24576
    v_mfma_f32_16x16x32_bf16 v[44:47], a[4:7], v[52:55], v[44:47]
    ds_read_b64_tr_b16 a[42:43], v90 offset:28672
    v_mfma_f32_16x16x32_bf16 v[56:59], a[8:11], v[48:51], v[56:59]
    ds_read_b64_tr_b16 a[44:45], v91 offset:24576
    ds_read_b64_tr_b16 a[46:47], v91 offset:28672
    v_mfma_f32_16x16x32_bf16 v[60:63], a[8:11], v[52:55], v[60:63]
    ds_read_b64_tr_b16 a[48:49], v92 offset:24576
    v_mfma_f32_16x16x32_bf16 v[72:75], a[12:15], v[48:51], v[72:75]
    ds_read_b64_tr_b16 a[50:51], v92 offset:28672
    ds_read_b64_tr_b16 a[52:53], v93 offset:24576
    v_mfma_f32_16x16x32_bf16 v[76:79], a[12:15], v[52:55], v[76:79]
    ds_read_b64_tr_b16 a[54:55], v93 offset:28672
    v_mfma_f32_16x16x32_bf16 a[96:99], a[16:19], v[48:51], a[96:99]
    ds_read_b64_tr_b16 a[56:57], v94 offset:24576
    ds_read_b64_tr_b16 a[58:59], v94 offset:28672
    v_mfma_f32_16x16x32_bf16 a[100:103], a[16:19], v[52:55], a[100:103]
    ds_read_b64_tr_b16 a[60:61], v95 offset:24576
    v_mfma_f32_16x16x32_bf16 a[104:107], a[20:23], v[48:51], a[104:107]
    ds_read_b64_tr_b16 a[62:63], v95 offset:28672
    v_mfma_f32_16x16x32_bf16 a[108:111], a[20:23], v[52:55], a[108:111]
    v_mfma_f32_16x16x32_bf16 a[112:115], a[24:27], v[48:51], a[112:115]
    v_mfma_f32_16x16x32_bf16 a[116:119], a[24:27], v[52:55], a[116:119]
    v_mfma_f32_16x16x32_bf16 a[120:123], a[28:31], v[48:51], a[120:123]
    v_mfma_f32_16x16x32_bf16 a[124:127], a[28:31], v[52:55], a[124:127]
    s_waitcnt lgkmcnt(0)
    s_barrier
    v_mfma_f32_16x16x32_bf16 v[24:27], a[32:35], v[64:67], v[24:27]
    ds_read_b64_tr_b16 a[0:1], v88 offset:32768
    ds_read_b64_tr_b16 a[2:3], v88 offset:36864
    v_mfma_f32_16x16x32_bf16 v[28:31], a[32:35], v[68:71], v[28:31]
    ds_read_b64_tr_b16 a[4:5], v89 offset:32768
    v_mfma_f32_16x16x32_bf16 v[40:43], a[36:39], v[64:67], v[40:43]
    ds_read_b64_tr_b16 a[6:7], v89 offset:36864
    ds_read_b64_tr_b16 a[8:9], v90 offset:32768
    v_mfma_f32_16x16x32_bf16 v[44:47], a[36:39], v[68:71], v[44:47]
    ds_read_b64_tr_b16 a[10:11], v90 offset:36864
    v_mfma_f32_16x16x32_bf16 v[56:59], a[40:43], v[64:67], v[56:59]
    ds_read_b64_tr_b16 a[12:13], v91 offset:32768
    ds_read_b64_tr_b16 a[14:15], v91 offset:36864
    v_mfma_f32_16x16x32_bf16 v[60:63], a[40:43], v[68:71], v[60:63]
    ds_read_b64_tr_b16 a[16:17], v92 offset:32768
    v_mfma_f32_16x16x32_bf16 v[72:75], a[44:47], v[64:67], v[72:75]
    ds_read_b64_tr_b16 a[18:19], v92 offset:36864
    ds_read_b64_tr_b16 a[20:21], v93 offset:32768
    v_mfma_f32_16x16x32_bf16 v[76:79], a[44:47], v[68:71], v[76:79]
    ds_read_b64_tr_b16 a[22:23], v93 offset:36864
    v_mfma_f32_16x16x32_bf16 a[96:99], a[48:51], v[64:67], a[96:99]
    ds_read_b64_tr_b16 a[24:25], v94 offset:32768
    ds_read_b64_tr_b16 a[26:27], v94 offset:36864
    v_mfma_f32_16x16x32_bf16 a[100:103], a[48:51], v[68:71], a[100:103]
    ds_read_b64_tr_b16 a[28:29], v95 offset:32768
    v_mfma_f32_16x16x32_bf16 a[104:107], a[52:55], v[64:67], a[104:107]
    ds_read_b64_tr_b16 a[30:31], v95 offset:36864
    v_mfma_f32_16x16x32_bf16 a[108:111], a[52:55], v[68:71], a[108:111]
    v_mfma_f32_16x16x32_bf16 a[112:115], a[56:59], v[64:67], a[112:115]
    v_mfma_f32_16x16x32_bf16 a[116:119], a[56:59], v[68:71], a[116:119]
    v_mfma_f32_16x16x32_bf16 a[120:123], a[60:63], v[64:67], a[120:123]
    v_mfma_f32_16x16x32_bf16 a[124:127], a[60:63], v[68:71], a[124:127]
    s_waitcnt lgkmcnt(0)
    buffer_load_dwordx2 v[8:9], v11, s[48:51], s87 offen sc1
    v_mfma_f32_16x16x32_bf16 v[24:27], a[0:3], v[80:83], v[24:27]
    ds_read_b64_tr_b16 a[32:33], v88 offset:40960
    ds_read_b64_tr_b16 a[34:35], v88 offset:45056
    v_mfma_f32_16x16x32_bf16 v[28:31], a[0:3], v[84:87], v[28:31]
    ds_read_b64_tr_b16 a[36:37], v89 offset:40960
    v_mfma_f32_16x16x32_bf16 v[40:43], a[4:7], v[80:83], v[40:43]
    ds_read_b64_tr_b16 a[38:39], v89 offset:45056
    ds_read_b64_tr_b16 a[40:41], v90 offset:40960
    v_mfma_f32_16x16x32_bf16 v[44:47], a[4:7], v[84:87], v[44:47]
    ds_read_b64_tr_b16 a[42:43], v90 offset:45056
    v_mfma_f32_16x16x32_bf16 v[56:59], a[8:11], v[80:83], v[56:59]
    ds_read_b64_tr_b16 a[44:45], v91 offset:40960
    ds_read_b64_tr_b16 a[46:47], v91 offset:45056
    v_mfma_f32_16x16x32_bf16 v[60:63], a[8:11], v[84:87], v[60:63]
    ds_read_b64_tr_b16 a[48:49], v92 offset:40960
    v_mfma_f32_16x16x32_bf16 v[72:75], a[12:15], v[80:83], v[72:75]
    ds_read_b64_tr_b16 a[50:51], v92 offset:45056
    ds_read_b64_tr_b16 a[52:53], v93 offset:40960
    v_mfma_f32_16x16x32_bf16 v[76:79], a[12:15], v[84:87], v[76:79]
    ds_read_b64_tr_b16 a[54:55], v93 offset:45056
    v_mfma_f32_16x16x32_bf16 a[96:99], a[16:19], v[80:83], a[96:99]
    ds_read_b64_tr_b16 a[56:57], v94 offset:40960
    ds_read_b64_tr_b16 a[58:59], v94 offset:45056
    v_mfma_f32_16x16x32_bf16 a[100:103], a[16:19], v[84:87], a[100:103]
    ds_read_b64_tr_b16 a[60:61], v95 offset:40960
    v_mfma_f32_16x16x32_bf16 a[104:107], a[20:23], v[80:83], a[104:107]
    ds_read_b64_tr_b16 a[62:63], v95 offset:45056
    v_mfma_f32_16x16x32_bf16 a[108:111], a[20:23], v[84:87], a[108:111]
    v_mfma_f32_16x16x32_bf16 a[112:115], a[24:27], v[80:83], a[112:115]
    v_mfma_f32_16x16x32_bf16 a[116:119], a[24:27], v[84:87], a[116:119]
    v_mfma_f32_16x16x32_bf16 a[120:123], a[28:31], v[80:83], a[120:123]
    v_mfma_f32_16x16x32_bf16 a[124:127], a[28:31], v[84:87], a[124:127]
    v_readfirstlane_b32 s20, v4
    s_lshl_b32 s16, s2, 2
    s_add_u32 s16, s16, s3
    s_lshl_b32 s16, s16, 13
    s_add_u32 s26, s16, 34603008
    s_add_u32 s27, s26, 4096
    s_xor_b32 s24, s26, 131072
    s_add_u32 s25, s24, 4096
    v_lshlrev_b32 v2, 4, v0
    s_lshr_b32 s16, s16, 6
    s_add_u32 s19, s16, 34078720
    s_xor_b32 s18, s19, 2048
    s_mul_i32 s20, s20, 0x01010101
    s_lshr_b32 s23, s20, 24
    s_bfe_u32 s22, s20, 0x80010
    s_bfe_u32 s21, s20, 0x80008
    s_and_b32 s20, s20, 0xff
    v_mov_b32 v14, 0xffffff00
    v_and_b32 v12, 7, v0
    v_lshlrev_b32 v12, 11, v12
    v_and_b32 v13, 8, v0
    v_lshl_add_u32 v12, v13, 3, v12
    s_mov_b32 s21, 16384
    s_lshl_b32 s15, s3, 16
    v_add_u32 v12, s15, v12
    v_and_b32 v13, 1, v3
    v_lshl_add_u32 v12, v13, 5, v12
    v_lshrrev_b32 v13, 1, v3
    v_lshl_add_u32 v12, v13, 4, v12
    v_add_u32 v13, 32768, v12
    s_mov_b32 s39, 0
    s_branch L_pc
L_pl:
    s_sleep 1
    buffer_load_dwordx2 v[8:9], v11, s[48:51], s87 offen sc1
    s_add_u32 s39, s39, 1
    s_cmp_gt_u32 s39, 0x80000
    s_cbranch_scc1 L_pd
L_pc:
    s_waitcnt vmcnt(0)
    v_cmp_ne_u64 vcc, v[8:9], v[4:5]
    s_cbranch_vccnz L_pl
L_pd:
    s_cmp_ge_u32 s95, s94
    s_cselect_b32 s17, 7, 0
    s_add_u32 s17, s17, s95
    s_lshl_b32 s96, s17, 13
    s_add_u32 s96, s96, s98
    s_add_u32 s95, s95, 1
    buffer_load_dwordx4 a[88:91], v1, s[48:51], s96 offen offset:0 sc1
    buffer_load_dwordx4 a[92:95], v1, s[48:51], s96 offen offset:1024 sc1
    s_cmp_ge_u32 s95, s94
    s_cselect_b32 s17, 7, 0
    s_add_u32 s17, s17, s95
    s_lshl_b32 s96, s17, 13
    s_add_u32 s96, s96, s98
    s_add_u32 s95, s95, 1
    buffer_load_dwordx4 v[16:19], v1, s[48:51], s96 offen offset:0 sc1
    buffer_load_dwordx4 v[20:23], v1, s[48:51], s96 offen offset:1024 sc1
    s_cmp_ge_u32 s95, s94
    s_cselect_b32 s17, 7, 0
    s_add_u32 s17, s17, s95
    s_lshl_b32 s96, s17, 13
    s_add_u32 s96, s96, s98
    s_add_u32 s95, s95, 1
    buffer_load_dwordx4 v[32:35], v1, s[48:51], s96 offen offset:0 sc1
    buffer_load_dwordx4 v[36:39], v1, s[48:51], s96 offen offset:1024 sc1
    s_waitcnt lgkmcnt(0)
    s_barrier
    v_mfma_f32_16x16x32_bf16 v[24:27], a[32:35], v[96:99], v[24:27]
    ds_read_b64_tr_b16 a[0:1], v88 offset:49152
    ds_read_b64_tr_b16 a[2:3], v88 offset:53248
    v_mfma_f32_16x16x32_bf16 v[28:31], a[32:35], v[100:103], v[28:31]
    ds_read_b64_tr_b16 a[4:5], v89 offset:49152
    v_mfma_f32_16x16x32_bf16 v[40:43], a[36:39], v[96:99], v[40:43]
    ds_read_b64_tr_b16 a[6:7], v89 offset:53248
    ds_read_b64_tr_b16 a[8:9], v90 offset:49152
    s_cmp_ge_u32 s95, s94
    s_cselect_b32 s17, 7, 0
    s_add_u32 s17, s17, s95
    v_mfma_f32_16x16x32_bf16 v[44:47], a[36:39], v[100:103], v[44:47]
    ds_read_b64_tr_b16 a[10:11], v90 offset:53248
    s_lshl_b32 s96, s17, 13
    s_add_u32 s96, s96, s98
    s_add_u32 s95, s95, 1
    v_mfma_f32_16x16x32_bf16 v[56:59], a[40:43], v[96:99], v[56:59]
    ds_read_b64_tr_b16 a[12:13], v91 offset:49152
    ds_read_b64_tr_b16 a[14:15], v91 offset:53248
    buffer_load_dwordx4 v[48:51], v1, s[48:51], s96 offen offset:0 sc1
    v_mfma_f32_16x16x32_bf16 v[60:63], a[40:43], v[100:103], v[60:63]
    ds_read_b64_tr_b16 a[16:17], v92 offset:49152
    v_mfma_f32_16x16x32_bf16 v[72:75], a[44:47], v[96:99], v[72:75]
    ds_read_b64_tr_b16 a[18:19], v92 offset:53248
    ds_read_b64_tr_b16 a[20:21], v93 offset:49152
    v_mfma_f32_16x16x32_bf16 v[76:79], a[44:47], v[100:103], v[76:79]
    ds_read_b64_tr_b16 a[22:23], v93 offset:53248
    buffer_load_dwordx4 v[52:55], v1, s[48:51], s96 offen offset:1024 sc1
    v_mfma_f32_16x16x32_bf16 a[96:99], a[48:51], v[96:99], a[96:99]
    ds_read_b64_tr_b16 a[24:25], v94 offset:49152
    ds_read_b64_tr_b16 a[26:27], v94 offset:53248
    v_mfma_f32_16x16x32_bf16 a[100:103], a[48:51], v[100:103], a[100:103]
    ds_read_b64_tr_b16 a[28:29], v95 offset:49152
    v_mfma_f32_16x16x32_bf16 a[104:107], a[52:55], v[96:99], a[104:107]
    ds_read_b64_tr_b16 a[30:31], v95 offset:53248
    v_mfma_f32_16x16x32_bf16 a[108:111], a[52:55], v[100:103], a[108:111]
    s_cmp_ge_u32 s95, s94
    s_cselect_b32 s17, 7, 0
    s_add_u32 s17, s17, s95
    v_mfma_f32_16x16x32_bf16 a[112:115], a[56:59], v[96:99], a[112:115]
    s_lshl_b32 s96, s17, 13
    s_add_u32 s96, s96, s98
    s_add_u32 s95, s95, 1
    v_mfma_f32_16x16x32_bf16 a[116:119], a[56:59], v[100:103], a[116:119]
    buffer_load_dwordx4 v[64:67], v1, s[48:51], s96 offen offset:0 sc1
    v_mfma_f32_16x16x32_bf16 a[120:123], a[60:63], v[96:99], a[120:123]
    v_mfma_f32_16x16x32_bf16 a[124:127], a[60:63], v[100:103], a[124:127]
    buffer_load_dwordx4 v[68:71], v1, s[48:51], s96 offen offset:1024 sc1
    s_waitcnt lgkmcnt(0)
    v_mfma_f32_16x16x32_bf16 v[24:27], a[0:3], v[112:115], v[24:27]
    ds_read_b64_tr_b16 a[32:33], v88 offset:57344
    ds_read_b64_tr_b16 a[34:35], v88 offset:61440
    v_mfma_f32_16x16x32_bf16 v[28:31], a[0:3], v[116:119], v[28:31]
    ds_read_b64_tr_b16 a[36:37], v89 offset:57344
    v_mfma_f32_16x16x32_bf16 v[40:43], a[4:7], v[112:115], v[40:43]
    ds_read_b64_tr_b16 a[38:39], v89 offset:61440
    ds_read_b64_tr_b16 a[40:41], v90 offset:57344
    s_cmp_ge_u32 s95, s94
    s_cselect_b32 s17, 7, 0
    s_add_u32 s17, s17, s95
    v_mfma_f32_16x16x32_bf16 v[44:47], a[4:7], v[116:119], v[44:47]
    ds_read_b64_tr_b16 a[42:43], v90 offset:61440
    s_lshl_b32 s96, s17, 13
    s_add_u32 s96, s96, s98
    s_add_u32 s95, s95, 1
    v_mfma_f32_16x16x32_bf16 v[56:59], a[8:11], v[112:115], v[56:59]
    ds_read_b64_tr_b16 a[44:45], v91 offset:57344
    ds_read_b64_tr_b16 a[46:47], v91 offset:61440
    buffer_load_dwordx4 a[64:67], v1, s[48:51], s96 offen offset:0 sc1
    v_mfma_f32_16x16x32_bf16 v[60:63], a[8:11], v[116:119], v[60:63]
    ds_read_b64_tr_b16 a[48:49], v92 offset:57344
    v_mfma_f32_16x16x32_bf16 v[72:75], a[12:15], v[112:115], v[72:75]
    ds_read_b64_tr_b16 a[50:51], v92 offset:61440
    ds_read_b64_tr_b16 a[52:53], v93 offset:57344
    v_mfma_f32_16x16x32_bf16 v[76:79], a[12:15], v[116:119], v[76:79]
    ds_read_b64_tr_b16 a[54:55], v93 offset:61440
    buffer_load_dwordx4 a[68:71], v1, s[48:51], s96 offen offset:1024 sc1
    v_mfma_f32_16x16x32_bf16 a[96:99], a[16:19], v[112:115], a[96:99]
    ds_read_b64_tr_b16 a[56:57], v94 offset:57344
    ds_read_b64_tr_b16 a[58:59], v94 offset:61440
    v_mfma_f32_16x16x32_bf16 a[100:103], a[16:19], v[116:119], a[100:103]
    ds_read_b64_tr_b16 a[60:61], v95 offset:57344
    v_mfma_f32_16x16x32_bf16 a[104:107], a[20:23], v[112:115], a[104:107]
    ds_read_b64_tr_b16 a[62:63], v95 offset:61440
    v_mfma_f32_16x16x32_bf16 a[108:111], a[20:23], v[116:119], a[108:111]
    s_cmp_ge_u32 s95, s94
    s_cselect_b32 s17, 7, 0
    s_add_u32 s17, s17, s95
    v_mfma_f32_16x16x32_bf16 a[112:115], a[24:27], v[112:115], a[112:115]
    s_lshl_b32 s96, s17, 13
    s_add_u32 s96, s96, s98
    s_add_u32 s95, s95, 1
    v_mfma_f32_16x16x32_bf16 a[116:119], a[24:27], v[116:119], a[116:119]
    buffer_load_dwordx4 a[72:75], v1, s[48:51], s96 offen offset:0 sc1
    v_mfma_f32_16x16x32_bf16 a[120:123], a[28:31], v[112:115], a[120:123]
    v_mfma_f32_16x16x32_bf16 a[124:127], a[28:31], v[116:119], a[124:127]
    buffer_load_dwordx4 a[76:79], v1, s[48:51], s96 offen offset:1024 sc1
    s_waitcnt vmcnt(12) lgkmcnt(0)
    s_barrier
    v_mfma_f32_16x16x32_bf16 v[24:27], a[32:35], a[88:91], v[24:27]
    ds_read_b64_tr_b16 a[0:1], v88 offset:0
    ds_read_b64_tr_b16 a[2:3], v88 offset:4096
    v_mfma_f32_16x16x32_bf16 v[28:31], a[32:35], a[92:95], v[28:31]
    ds_read_b64_tr_b16 a[4:5], v89 offset:0
    v_mfma_f32_16x16x32_bf16 v[40:43], a[36:39], a[88:91], v[40:43]
    ds_read_b64_tr_b16 a[6:7], v89 offset:4096
    ds_read_b64_tr_b16 a[8:9], v90 offset:0
    v_mfma_f32_16x16x32_bf16 v[44:47], a[36:39], a[92:95], v[44:47]
    ds_read_b64_tr_b16 a[10:11], v90 offset:4096
    v_mfma_f32_16x16x32_bf16 v[56:59], a[40:43], a[88:91], v[56:59]
    ds_read_b64_tr_b16 a[12:13], v91 offset:0
    ds_read_b64_tr_b16 a[14:15], v91 offset:4096
    v_mfma_f32_16x16x32_bf16 v[60:63], a[40:43], a[92:95], v[60:63]
    ds_read_b64_tr_b16 a[16:17], v92 offset:0
    v_mfma_f32_16x16x32_bf16 v[72:75], a[44:47], a[88:91], v[72:75]
    ds_read_b64_tr_b16 a[18:19], v92 offset:4096
    ds_read_b64_tr_b16 a[20:21], v93 offset:0
    v_mfma_f32_16x16x32_bf16 v[76:79], a[44:47], a[92:95], v[76:79]
    ds_read_b64_tr_b16 a[22:23], v93 offset:4096
    v_mfma_f32_16x16x32_bf16 a[96:99], a[48:51], a[88:91], a[96:99]
    ds_read_b64_tr_b16 a[24:25], v94 offset:0
    ds_read_b64_tr_b16 a[26:27], v94 offset:4096
    v_mfma_f32_16x16x32_bf16 a[100:103], a[48:51], a[92:95], a[100:103]
    ds_read_b64_tr_b16 a[28:29], v95 offset:0
    v_mfma_f32_16x16x32_bf16 a[104:107], a[52:55], a[88:91], a[104:107]
    ds_read_b64_tr_b16 a[30:31], v95 offset:4096
    v_mfma_f32_16x16x32_bf16 a[108:111], a[52:55], a[92:95], a[108:111]
    s_cmp_ge_u32 s95, s94
    s_cselect_b32 s17, 7, 0
    s_add_u32 s17, s17, s95
    v_mfma_f32_16x16x32_bf16 a[112:115], a[56:59], a[88:91], a[112:115]
    s_lshl_b32 s96, s17, 13
    s_add_u32 s96, s96, s98
    s_add_u32 s95, s95, 1
    v_mfma_f32_16x16x32_bf16 a[116:119], a[56:59], a[92:95], a[116:119]
    buffer_load_dwordx4 a[80:83], v1, s[48:51], s96 offen offset:0 sc1
    v_mfma_f32_16x16x32_bf16 a[120:123], a[60:63], a[88:91], a[120:123]
    v_mfma_f32_16x16x32_bf16 a[124:127], a[60:63], a[92:95], a[124:127]
    buffer_load_dwordx4 a[84:87], v1, s[48:51], s96 offen offset:1024 sc1
    s_mov_b32 s39, 0
L2_loop:
    s_waitcnt vmcnt(12) lgkmcnt(0)
    v_mfma_f32_16x16x32_bf16 v[24:27], a[0:3], v[16:19], v[24:27]
    ds_read_b64_tr_b16 a[32:33], v88 offset:8192
    ds_read_b64_tr_b16 a[34:35], v88 offset:12288
    v_mfma_f32_16x16x32_bf16 v[28:31], a[0:3], v[20:23], v[28:31]
    ds_read_b64_tr_b16 a[36:37], v89 offset:8192
    v_mfma_f32_16x16x32_bf16 v[40:43], a[4:7], v[16:19], v[40:43]
    ds_read_b64_tr_b16 a[38:39], v89 offset:12288
    ds_read_b64_tr_b16 a[40:41], v90 offset:8192
    v_mfma_f32_16x16x32_bf16 v[44:47], a[4:7], v[20:23], v[44:47]
    ds_read_b64_tr_b16 a[42:43], v90 offset:12288
    v_mfma_f32_16x16x32_bf16 v[56:59], a[8:11], v[16:19], v[56:59]
    ds_read_b64_tr_b16 a[44:45], v91 offset:8192
    ds_read_b64_tr_b16 a[46:47], v91 offset:12288
    v_mfma_f32_16x16x32_bf16 v[60:63], a[8:11], v[20:23], v[60:63]
    ds_read_b64_tr_b16 a[48:49], v92 offset:8192
    v_mfma_f32_16x16x32_bf16 v[72:75], a[12:15], v[16:19], v[72:75]
    ds_read_b64_tr_b16 a[50:51], v92 offset:12288
    ds_read_b64_tr_b16 a[52:53], v93 offset:8192
    v_mfma_f32_16x16x32_bf16 v[76:79], a[12:15], v[20:23], v[76:79]
    ds_read_b64_tr_b16 a[54:55], v93 offset:12288
    v_mfma_f32_16x16x32_bf16 a[96:99], a[16:19], v[16:19], a[96:99]
    ds_read_b64_tr_b16 a[56:57], v94 offset:8192
    ds_read_b64_tr_b16 a[58:59], v94 offset:12288
    v_mfma_f32_16x16x32_bf16 a[100:103], a[16:19], v[20:23], a[100:103]
    ds_read_b64_tr_b16 a[60:61], v95 offset:8192
    v_mfma_f32_16x16x32_bf16 a[104:107], a[20:23], v[16:19], a[104:107]
    ds_read_b64_tr_b16 a[62:63], v95 offset:12288
    v_mfma_f32_16x16x32_bf16 a[108:111], a[20:23], v[20:23], a[108:111]
    s_cmp_ge_u32 s95, s94
    s_cselect_b32 s17, 7, 0
    s_add_u32 s17, s17, s95
    v_mfma_f32_16x16x32_bf16 a[112:115], a[24:27], v[16:19], a[112:115]
    s_lshl_b32 s96, s17, 13
    s_add_u32 s96, s96, s98
    s_add_u32 s95, s95, 1
    v_mfma_f32_16x16x32_bf16 a[116:119], a[24:27], v[20:23], a[116:119]
    buffer_load_dwordx4 a[88:91], v1, s[48:51], s96 offen offset:0 sc1
    v_mfma_f32_16x16x32_bf16 a[120:123], a[28:31], v[16:19], a[120:123]
    v_mfma_f32_16x16x32_bf16 a[124:127], a[28:31], v[20:23], a[124:127]
    buffer_load_dwordx4 a[92:95], v1, s[48:51], s96 offen offset:1024 sc1
    s_waitcnt vmcnt(12) lgkmcnt(0)
    s_barrier
    v_mfma_f32_16x16x32_bf16 v[24:27], a[32:35], v[32:35], v[24:27]
    ds_read_b64_tr_b16 a[0:1], v88 offset:16384
    ds_read_b64_tr_b16 a[2:3], v88 offset:20480
    v_mfma_f32_16x16x32_bf16 v[28:31], a[32:35], v[36:39], v[28:31]
    ds_read_b64_tr_b16 a[4:5], v89 offset:16384
    v_mfma_f32_16x16x32_bf16 v[40:43], a[36:39], v[32:35], v[40:43]
    ds_read_b64_tr_b16 a[6:7], v89 offset:20480
    ds_read_b64_tr_b16 a[8:9], v90 offset:16384
    v_mfma_f32_16x16x32_bf16 v[44:47], a[36:39], v[36:39], v[44:47]
    ds_read_b64_tr_b16 a[10:11], v90 offset:20480
    v_mfma_f32_16x16x32_bf16 v[56:59], a[40:43], v[32:35], v[56:59]
    ds_read_b64_tr_b16 a[12:13], v91 offset:16384
    ds_read_b64_tr_b16 a[14:15], v91 offset:20480
    v_mfma_f32_16x16x32_bf16 v[60:63], a[40:43], v[36:39], v[60:63]
    ds_read_b64_tr_b16 a[16:17], v92 offset:16384
    v_mfma_f32_16x16x32_bf16 v[72:75], a[44:47], v[32:35], v[72:75]
    ds_read_b64_tr_b16 a[18:19], v92 offset:20480
    ds_read_b64_tr_b16 a[20:21], v93 offset:16384
    v_mfma_f32_16x16x32_bf16 v[76:79], a[44:47], v[36:39], v[76:79]
    ds_read_b64_tr_b16 a[22:23], v93 offset:20480
    v_mfma_f32_16x16x32_bf16 a[96:99], a[48:51], v[32:35], a[96:99]
    ds_read_b64_tr_b16 a[24:25], v94 offset:16384
    ds_read_b64_tr_b16 a[26:27], v94 offset:20480
    v_mfma_f32_16x16x32_bf16 a[100:103], a[48:51], v[36:39], a[100:103]
    ds_read_b64_tr_b16 a[28:29], v95 offset:16384
    v_mfma_f32_16x16x32_bf16 a[104:107], a[52:55], v[32:35], a[104:107]
    ds_read_b64_tr_b16 a[30:31], v95 offset:20480
    v_mfma_f32_16x16x32_bf16 a[108:111], a[52:55], v[36:39], a[108:111]
    s_cmp_ge_u32 s95, s94
    s_cselect_b32 s17, 7, 0
    s_add_u32 s17, s17, s95
    v_mfma_f32_16x16x32_bf16 a[112:115], a[56:59], v[32:35], a[112:115]
    s_lshl_b32 s96, s17, 13
    s_add_u32 s96, s96, s98
    s_add_u32 s95, s95, 1
    v_mfma_f32_16x16x32_bf16 a[116:119], a[56:59], v[36:39], a[116:119]
    buffer_load_dwordx4 v[16:19], v1, s[48:51], s96 offen offset:0 sc1
    v_mfma_f32_16x16x32_bf16 a[120:123], a[60:63], v[32:35], a[120:123]
    v_mfma_f32_16x16x32_bf16 a[124:127], a[60:63], v[36:39], a[124:127]
    buffer_load_dwordx4 v[20:23], v1, s[48:51], s96 offen offset:1024 sc1
    s_waitcnt vmcnt(12) lgkmcnt(0)
    v_mfma_f32_16x16x32_bf16 v[24:27], a[0:3], v[48:51], v[24:27]
    ds_read_b64_tr_b16 a[32:33], v88 offset:24576
    ds_read_b64_tr_b16 a[34:35], v88 offset:28672
    v_mfma_f32_16x16x32_bf16 v[28:31], a[0:3], v[52:55], v[28:31]
    ds_read_b64_tr_b16 a[36:37], v89 offset:24576
    v_mfma_f32_16x16x32_bf16 v[40:43], a[4:7], v[48:51], v[40:43]
    ds_read_b64_tr_b16 a[38:39], v89 offset:28672
    ds_read_b64_tr_b16 a[40:41], v90 offset:24576
    v_mfma_f32_16x16x32_bf16 v[44:47], a[4:7], v[52:55], v[44:47]
    ds_read_b64_tr_b16 a[42:43], v90 offset:28672
    v_mfma_f32_16x16x32_bf16 v[56:59], a[8:11], v[48:51], v[56:59]
    ds_read_b64_tr_b16 a[44:45], v91 offset:24576
    ds_read_b64_tr_b16 a[46:47], v91 offset:28672
    v_mfma_f32_16x16x32_bf16 v[60:63], a[8:11], v[52:55], v[60:63]
    ds_read_b64_tr_b16 a[48:49], v92 offset:24576
    v_mfma_f32_16x16x32_bf16 v[72:75], a[12:15], v[48:51], v[72:75]
    ds_read_b64_tr_b16 a[50:51], v92 offset:28672
    ds_read_b64_tr_b16 a[52:53], v93 offset:24576
    v_mfma_f32_16x16x32_bf16 v[76:79], a[12:15], v[52:55], v[76:79]
    ds_read_b64_tr_b16 a[54:55], v93 offset:28672
    v_mfma_f32_16x16x32_bf16 a[96:99], a[16:19], v[48:51], a[96:99]
    ds_read_b64_tr_b16 a[56:57], v94 offset:24576
    ds_read_b64_tr_b16 a[58:59], v94 offset:28672
    v_mfma_f32_16x16x32_bf16 a[100:103], a[16:19], v[52:55], a[100:103]
    ds_read_b64_tr_b16 a[60:61], v95 offset:24576
    v_mfma_f32_16x16x32_bf16 a[104:107], a[20:23], v[48:51], a[104:107]
    ds_read_b64_tr_b16 a[62:63], v95 offset:28672
    v_mfma_f32_16x16x32_bf16 a[108:111], a[20:23], v[52:55], a[108:111]
    s_cmp_ge_u32 s95, s94
    s_cselect_b32 s17, 7, 0
    s_add_u32 s17, s17, s95
    v_mfma_f32_16x16x32_bf16 a[112:115], a[24:27], v[48:51], a[112:115]
    s_lshl_b32 s96, s17, 13
    s_add_u32 s96, s96, s98
    s_add_u32 s95, s95, 1
    v_mfma_f32_16x16x32_bf16 a[116:119], a[24:27], v[52:55], a[116:119]
    buffer_load_dwordx4 v[32:35], v1, s[48:51], s96 offen offset:0 sc1
    v_mfma_f32_16x16x32_bf16 a[120:123], a[28:31], v[48:51], a[120:123]
    v_mfma_f32_16x16x32_bf16 a[124:127], a[28:31], v[52:55], a[124:127]
    buffer_load_dwordx4 v[36:39], v1, s[48:51], s96 offen offset:1024 sc1
    s_waitcnt vmcnt(12) lgkmcnt(0)
    s_barrier
    v_mfma_f32_16x16x32_bf16 v[24:27], a[32:35], v[64:67], v[24:27]
    ds_read_b64_tr_b16 a[0:1], v88 offset:32768
    ds_read_b64_tr_b16 a[2:3], v88 offset:36864
    v_mfma_f32_16x16x32_bf16 v[28:31], a[32:35], v[68:71], v[28:31]
    ds_read_b64_tr_b16 a[4:5], v89 offset:32768
    v_mfma_f32_16x16x32_bf16 v[40:43], a[36:39], v[64:67], v[40:43]
    ds_read_b64_tr_b16 a[6:7], v89 offset:36864
    ds_read_b64_tr_b16 a[8:9], v90 offset:32768
    v_mfma_f32_16x16x32_bf16 v[44:47], a[36:39], v[68:71], v[44:47]
    ds_read_b64_tr_b16 a[10:11], v90 offset:36864
    v_mfma_f32_16x16x32_bf16 v[56:59], a[40:43], v[64:67], v[56:59]
    ds_read_b64_tr_b16 a[12:13], v91 offset:32768
    ds_read_b64_tr_b16 a[14:15], v91 offset:36864
    v_mfma_f32_16x16x32_bf16 v[60:63], a[40:43], v[68:71], v[60:63]
    ds_read_b64_tr_b16 a[16:17], v92 offset:32768
    v_mfma_f32_16x16x32_bf16 v[72:75], a[44:47], v[64:67], v[72:75]
    ds_read_b64_tr_b16 a[18:19], v92 offset:36864
    ds_read_b64_tr_b16 a[20:21], v93 offset:32768
    v_mfma_f32_16x16x32_bf16 v[76:79], a[44:47], v[68:71], v[76:79]
    ds_read_b64_tr_b16 a[22:23], v93 offset:36864
    v_mfma_f32_16x16x32_bf16 a[96:99], a[48:51], v[64:67], a[96:99]
    ds_read_b64_tr_b16 a[24:25], v94 offset:32768
    ds_read_b64_tr_b16 a[26:27], v94 offset:36864
    v_mfma_f32_16x16x32_bf16 a[100:103], a[48:51], v[68:71], a[100:103]
    ds_read_b64_tr_b16 a[28:29], v95 offset:32768
    v_mfma_f32_16x16x32_bf16 a[104:107], a[52:55], v[64:67], a[104:107]
    ds_read_b64_tr_b16 a[30:31], v95 offset:36864
    v_mfma_f32_16x16x32_bf16 a[108:111], a[52:55], v[68:71], a[108:111]
    s_cmp_ge_u32 s95, s94
    s_cselect_b32 s17, 7, 0
    s_add_u32 s17, s17, s95
    v_mfma_f32_16x16x32_bf16 a[112:115], a[56:59], v[64:67], a[112:115]
    s_lshl_b32 s96, s17, 13
    s_add_u32 s96, s96, s98
    s_add_u32 s95, s95, 1
    v_mfma_f32_16x16x32_bf16 a[116:119], a[56:59], v[68:71], a[116:119]
    buffer_load_dwordx4 v[48:51], v1, s[48:51], s96 offen offset:0 sc1
    v_mfma_f32_16x16x32_bf16 a[120:123], a[60:63], v[64:67], a[120:123]
    v_mfma_f32_16x16x32_bf16 a[124:127], a[60:63], v[68:71], a[124:127]
    buffer_load_dwordx4 v[52:55], v1, s[48:51], s96 offen offset:1024 sc1
    s_waitcnt vmcnt(12) lgkmcnt(0)
    v_mfma_f32_16x16x32_bf16 v[24:27], a[0:3], a[64:67], v[24:27]
    ds_read_b64_tr_b16 a[32:33], v88 offset:40960
    ds_read_b64_tr_b16 a[34:35], v88 offset:45056
    v_mfma_f32_16x16x32_bf16 v[28:31], a[0:3], a[68:71], v[28:31]
    ds_read_b64_tr_b16 a[36:37], v89 offset:40960
    v_mfma_f32_16x16x32_bf16 v[40:43], a[4:7], a[64:67], v[40:43]
    ds_read_b64_tr_b16 a[38:39], v89 offset:45056
    ds_read_b64_tr_b16 a[40:41], v90 offset:40960
    v_mfma_f32_16x16x32_bf16 v[44:47], a[4:7], a[68:71], v[44:47]
    ds_read_b64_tr_b16 a[42:43], v90 offset:45056
    v_mfma_f32_16x16x32_bf16 v[56:59], a[8:11], a[64:67], v[56:59]
    ds_read_b64_tr_b16 a[44:45], v91 offset:40960
    ds_read_b64_tr_b16 a[46:47], v91 offset:45056
    v_mfma_f32_16x16x32_bf16 v[60:63], a[8:11], a[68:71], v[60:63]
    ds_read_b64_tr_b16 a[48:49], v92 offset:40960
    v_mfma_f32_16x16x32_bf16 v[72:75], a[12:15], a[64:67], v[72:75]
    ds_read_b64_tr_b16 a[50:51], v92 offset:45056
    ds_read_b64_tr_b16 a[52:53], v93 offset:40960
    v_mfma_f32_16x16x32_bf16 v[76:79], a[12:15], a[68:71], v[76:79]
    ds_read_b64_tr_b16 a[54:55], v93 offset:45056
    v_mfma_f32_16x16x32_bf16 a[96:99], a[16:19], a[64:67], a[96:99]
    ds_read_b64_tr_b16 a[56:57], v94 offset:40960
    ds_read_b64_tr_b16 a[58:59], v94 offset:45056
    v_mfma_f32_16x16x32_bf16 a[100:103], a[16:19], a[68:71], a[100:103]
    ds_read_b64_tr_b16 a[60:61], v95 offset:40960
    v_mfma_f32_16x16x32_bf16 a[104:107], a[20:23], a[64:67], a[104:107]
    ds_read_b64_tr_b16 a[62:63], v95 offset:45056
    v_mfma_f32_16x16x32_bf16 a[108:111], a[20:23], a[68:71], a[108:111]
    s_cmp_ge_u32 s95, s94
    s_cselect_b32 s17, 7, 0
    s_add_u32 s17, s17, s95
    v_mfma_f32_16x16x32_bf16 a[112:115], a[24:27], a[64:67], a[112:115]
    s_lshl_b32 s96, s17, 13
    s_add_u32 s96, s96, s98
    s_add_u32 s95, s95, 1
    v_mfma_f32_16x16x32_bf16 a[116:119], a[24:27], a[68:71], a[116:119]
    buffer_load_dwordx4 v[64:67], v1, s[48:51], s96 offen offset:0 sc1
    v_mfma_f32_16x16x32_bf16 a[120:123], a[28:31], a[64:67], a[120:123]
    v_mfma_f32_16x16x32_bf16 a[124:127], a[28:31], a[68:71], a[124:127]
    buffer_load_dwordx4 v[68:71], v1, s[48:51], s96 offen offset:1024 sc1
    s_waitcnt vmcnt(12) lgkmcnt(0)
    s_barrier
    v_mfma_f32_16x16x32_bf16 v[24:27], a[32:35], a[72:75], v[24:27]
    ds_read_b64_tr_b16 a[0:1], v88 offset:49152
    ds_read_b64_tr_b16 a[2:3], v88 offset:53248
    v_mfma_f32_16x16x32_bf16 v[28:31], a[32:35], a[76:79], v[28:31]
    ds_read_b64_tr_b16 a[4:5], v89 offset:49152
    v_mfma_f32_16x16x32_bf16 v[40:43], a[36:39], a[72:75], v[40:43]
    ds_read_b64_tr_b16 a[6:7], v89 offset:53248
    ds_read_b64_tr_b16 a[8:9], v90 offset:49152
    v_mfma_f32_16x16x32_bf16 v[44:47], a[36:39], a[76:79], v[44:47]
    ds_read_b64_tr_b16 a[10:11], v90 offset:53248
    v_mfma_f32_16x16x32_bf16 v[56:59], a[40:43], a[72:75], v[56:59]
    ds_read_b64_tr_b16 a[12:13], v91 offset:49152
    ds_read_b64_tr_b16 a[14:15], v91 offset:53248
    v_mfma_f32_16x16x32_bf16 v[60:63], a[40:43], a[76:79], v[60:63]
    ds_read_b64_tr_b16 a[16:17], v92 offset:49152
    v_mfma_f32_16x16x32_bf16 v[72:75], a[44:47], a[72:75], v[72:75]
    ds_read_b64_tr_b16 a[18:19], v92 offset:53248
    ds_read_b64_tr_b16 a[20:21], v93 offset:49152
    v_mfma_f32_16x16x32_bf16 v[76:79], a[44:47], a[76:79], v[76:79]
    ds_read_b64_tr_b16 a[22:23], v93 offset:53248
    v_mfma_f32_16x16x32_bf16 a[96:99], a[48:51], a[72:75], a[96:99]
    ds_read_b64_tr_b16 a[24:25], v94 offset:49152
    ds_read_b64_tr_b16 a[26:27], v94 offset:53248
    v_mfma_f32_16x16x32_bf16 a[100:103], a[48:51], a[76:79], a[100:103]
    ds_read_b64_tr_b16 a[28:29], v95 offset:49152
    v_mfma_f32_16x16x32_bf16 a[104:107], a[52:55], a[72:75], a[104:107]
    ds_read_b64_tr_b16 a[30:31], v95 offset:53248
    v_mfma_f32_16x16x32_bf16 a[108:111], a[52:55], a[76:79], a[108:111]
    s_cmp_ge_u32 s95, s94
    s_cselect_b32 s17, 7, 0
    s_add_u32 s17, s17, s95
    v_mfma_f32_16x16x32_bf16 a[112:115], a[56:59], a[72:75], a[112:115]
    s_lshl_b32 s96, s17, 13
    s_add_u32 s96, s96, s98
    s_add_u32 s95, s95, 1
    v_mfma_f32_16x16x32_bf16 a[116:119], a[56:59], a[76:79], a[116:119]
    buffer_load_dwordx4 a[64:67], v1, s[48:51], s96 offen offset:0 sc1
    v_mfma_f32_16x16x32_bf16 a[120:123], a[60:63], a[72:75], a[120:123]
    v_mfma_f32_16x16x32_bf16 a[124:127], a[60:63], a[76:79], a[124:127]
    buffer_load_dwordx4 a[68:71], v1, s[48:51], s96 offen offset:1024 sc1
    s_waitcnt vmcnt(12) lgkmcnt(0)
    v_mfma_f32_16x16x32_bf16 v[24:27], a[0:3], a[80:83], v[24:27]
    ds_read_b64_tr_b16 a[32:33], v88 offset:57344
    ds_read_b64_tr_b16 a[34:35], v88 offset:61440
    v_mfma_f32_16x16x32_bf16 v[28:31], a[0:3], a[84:87], v[28:31]
    ds_read_b64_tr_b16 a[36:37], v89 offset:57344
    v_mfma_f32_16x16x32_bf16 v[40:43], a[4:7], a[80:83], v[40:43]
    ds_read_b64_tr_b16 a[38:39], v89 offset:61440
    ds_read_b64_tr_b16 a[40:41], v90 offset:57344
    v_mfma_f32_16x16x32_bf16 v[44:47], a[4:7], a[84:87], v[44:47]
    ds_read_b64_tr_b16 a[42:43], v90 offset:61440
    v_mfma_f32_16x16x32_bf16 v[56:59], a[8:11], a[80:83], v[56:59]
    ds_read_b64_tr_b16 a[44:45], v91 offset:57344
    ds_read_b64_tr_b16 a[46:47], v91 offset:61440
    v_mfma_f32_16x16x32_bf16 v[60:63], a[8:11], a[84:87], v[60:63]
    ds_read_b64_tr_b16 a[48:49], v92 offset:57344
    v_mfma_f32_16x16x32_bf16 v[72:75], a[12:15], a[80:83], v[72:75]
    ds_read_b64_tr_b16 a[50:51], v92 offset:61440
    ds_read_b64_tr_b16 a[52:53], v93 offset:57344
    v_mfma_f32_16x16x32_bf16 v[76:79], a[12:15], a[84:87], v[76:79]
    ds_read_b64_tr_b16 a[54:55], v93 offset:61440
    v_mfma_f32_16x16x32_bf16 a[96:99], a[16:19], a[80:83], a[96:99]
    ds_read_b64_tr_b16 a[56:57], v94 offset:57344
    ds_read_b64_tr_b16 a[58:59], v94 offset:61440
    v_mfma_f32_16x16x32_bf16 a[100:103], a[16:19], a[84:87], a[100:103]
    ds_read_b64_tr_b16 a[60:61], v95 offset:57344
    v_mfma_f32_16x16x32_bf16 a[104:107], a[20:23], a[80:83], a[104:107]
    ds_read_b64_tr_b16 a[62:63], v95 offset:61440
    v_mfma_f32_16x16x32_bf16 a[108:111], a[20:23], a[84:87], a[108:111]
    s_cmp_ge_u32 s95, s94
    s_cselect_b32 s17, 7, 0
    s_add_u32 s17, s17, s95
    v_mfma_f32_16x16x32_bf16 a[112:115], a[24:27], a[80:83], a[112:115]
    s_lshl_b32 s96, s17, 13
    s_add_u32 s96, s96, s98
    s_add_u32 s95, s95, 1
    v_mfma_f32_16x16x32_bf16 a[116:119], a[24:27], a[84:87], a[116:119]
    buffer_load_dwordx4 a[72:75], v1, s[48:51], s96 offen offset:0 sc1
    v_mfma_f32_16x16x32_bf16 a[120:123], a[28:31], a[80:83], a[120:123]
    v_mfma_f32_16x16x32_bf16 a[124:127], a[28:31], a[84:87], a[124:127]
    buffer_load_dwordx4 a[76:79], v1, s[48:51], s96 offen offset:1024 sc1
    s_waitcnt vmcnt(12) lgkmcnt(0)
    s_barrier
    v_mfma_f32_16x16x32_bf16 v[24:27], a[32:35], a[88:91], v[24:27]
    ds_read_b64_tr_b16 a[0:1], v88 offset:0
    ds_read_b64_tr_b16 a[2:3], v88 offset:4096
    v_mfma_f32_16x16x32_bf16 v[28:31], a[32:35], a[92:95], v[28:31]
    ds_read_b64_tr_b16 a[4:5], v89 offset:0
    v_mfma_f32_16x16x32_bf16 v[40:43], a[36:39], a[88:91], v[40:43]
    ds_read_b64_tr_b16 a[6:7], v89 offset:4096
    ds_read_b64_tr_b16 a[8:9], v90 offset:0
    v_mfma_f32_16x16x32_bf16 v[44:47], a[36:39], a[92:95], v[44:47]
    ds_read_b64_tr_b16 a[10:11], v90 offset:4096
    v_mfma_f32_16x16x32_bf16 v[56:59], a[40:43], a[88:91], v[56:59]
    ds_read_b64_tr_b16 a[12:13], v91 offset:0
    ds_read_b64_tr_b16 a[14:15], v91 offset:4096
    v_mfma_f32_16x16x32_bf16 v[60:63], a[40:43], a[92:95], v[60:63]
    ds_read_b64_tr_b16 a[16:17], v92 offset:0
    v_mfma_f32_16x16x32_bf16 v[72:75], a[44:47], a[88:91], v[72:75]
    ds_read_b64_tr_b16 a[18:19], v92 offset:4096
    ds_read_b64_tr_b16 a[20:21], v93 offset:0
    v_mfma_f32_16x16x32_bf16 v[76:79], a[44:47], a[92:95], v[76:79]
    ds_read_b64_tr_b16 a[22:23], v93 offset:4096
    v_mfma_f32_16x16x32_bf16 a[96:99], a[48:51], a[88:91], a[96:99]
    ds_read_b64_tr_b16 a[24:25], v94 offset:0
    ds_read_b64_tr_b16 a[26:27], v94 offset:4096
    v_mfma_f32_16x16x32_bf16 a[100:103], a[48:51], a[92:95], a[100:103]
    ds_read_b64_tr_b16 a[28:29], v95 offset:0
    v_mfma_f32_16x16x32_bf16 a[104:107], a[52:55], a[88:91], a[104:107]
    ds_read_b64_tr_b16 a[30:31], v95 offset:4096
    v_mfma_f32_16x16x32_bf16 a[108:111], a[52:55], a[92:95], a[108:111]
    s_cmp_ge_u32 s95, s94
    s_cselect_b32 s17, 7, 0
    s_add_u32 s17, s17, s95
    v_mfma_f32_16x16x32_bf16 a[112:115], a[56:59], a[88:91], a[112:115]
    s_lshl_b32 s96, s17, 13
    s_add_u32 s96, s96, s98
    s_add_u32 s95, s95, 1
    v_mfma_f32_16x16x32_bf16 a[116:119], a[56:59], a[92:95], a[116:119]
    buffer_load_dwordx4 a[80:83], v1, s[48:51], s96 offen offset:0 sc1
    v_mfma_f32_16x16x32_bf16 a[120:123], a[60:63], a[88:91], a[120:123]
    s_add_u32 s39, s39, 1
    s_cmp_lt_u32 s39, 5
    v_mfma_f32_16x16x32_bf16 a[124:127], a[60:63], a[92:95], a[124:127]
    buffer_load_dwordx4 a[84:87], v1, s[48:51], s96 offen offset:1024 sc1
    s_cbranch_scc1 L2_loop
    s_waitcnt vmcnt(12) lgkmcnt(0)
    v_mfma_f32_16x16x32_bf16 v[24:27], a[0:3], v[16:19], v[24:27]
    ds_read_b64_tr_b16 a[32:33], v88 offset:8192
    ds_read_b64_tr_b16 a[34:35], v88 offset:12288
    v_mfma_f32_16x16x32_bf16 v[28:31], a[0:3], v[20:23], v[28:31]
    ds_read_b64_tr_b16 a[36:37], v89 offset:8192
    s_cmp_ge_u32 s95, s94
    s_cselect_b32 s17, 7, 0
    s_add_u32 s17, s17, s95
    v_mfma_f32_16x16x32_bf16 v[40:43], a[4:7], v[16:19], v[40:43]
    ds_read_b64_tr_b16 a[38:39], v89 offset:12288
    ds_read_b64_tr_b16 a[40:41], v90 offset:8192
    s_lshl_b32 s96, s17, 13
    s_add_u32 s96, s96, s98
    s_add_u32 s95, s95, 1
    v_mfma_f32_16x16x32_bf16 v[44:47], a[4:7], v[20:23], v[44:47]
    ds_read_b64_tr_b16 a[42:43], v90 offset:12288
    buffer_load_dwordx4 a[88:91], v1, s[48:51], s96 offen offset:0 sc1
    v_mfma_f32_16x16x32_bf16 v[56:59], a[8:11], v[16:19], v[56:59]
    ds_read_b64_tr_b16 a[44:45], v91 offset:8192
    ds_read_b64_tr_b16 a[46:47], v91 offset:12288
    v_mfma_f32_16x16x32_bf16 v[60:63], a[8:11], v[20:23], v[60:63]
    ds_read_b64_tr_b16 a[48:49], v92 offset:8192
    buffer_load_dwordx4 a[92:95], v1, s[48:51], s96 offen offset:1024 sc1
    v_mfma_f32_16x16x32_bf16 v[72:75], a[12:15], v[16:19], v[72:75]
    ds_read_b64_tr_b16 a[50:51], v92 offset:12288
    ds_read_b64_tr_b16 a[52:53], v93 offset:8192
    v_mfma_f32_16x16x32_bf16 v[76:79], a[12:15], v[20:23], v[76:79]
    ds_read_b64_tr_b16 a[54:55], v93 offset:12288
    v_mfma_f32_16x16x32_bf16 a[96:99], a[16:19], v[16:19], a[96:99]
    ds_read_b64_tr_b16 a[56:57], v94 offset:8192
    ds_read_b64_tr_b16 a[58:59], v94 offset:12288
    v_mfma_f32_16x16x32_bf16 a[100:103], a[16:19], v[20:23], a[100:103]
    ds_read_b64_tr_b16 a[60:61], v95 offset:8192
    v_mfma_f32_16x16x32_bf16 a[104:107], a[20:23], v[16:19], a[104:107]
    ds_read_b64_tr_b16 a[62:63], v95 offset:12288
    v_mfma_f32_16x16x32_bf16 a[108:111], a[20:23], v[20:23], a[108:111]
    v_mfma_f32_16x16x32_bf16 a[112:115], a[24:27], v[16:19], a[112:115]
    v_mfma_f32_16x16x32_bf16 a[116:119], a[24:27], v[20:23], a[116:119]
    v_mfma_f32_16x16x32_bf16 a[120:123], a[28:31], v[16:19], a[120:123]
    v_mfma_f32_16x16x32_bf16 a[124:127], a[28:31], v[20:23], a[124:127]
    s_waitcnt vmcnt(12) lgkmcnt(0)
    s_barrier
    v_mfma_f32_16x16x32_bf16 v[24:27], a[32:35], v[32:35], v[24:27]
    ds_read_b64_tr_b16 a[0:1], v92 offset:16384
    ds_read_b64_tr_b16 a[2:3], v92 offset:20480
    v_mfma_f32_16x16x32_bf16 v[28:31], a[32:35], v[36:39], v[28:31]
    ds_read_b64_tr_b16 a[4:5], v93 offset:16384
    v_mfma_f32_16x16x32_bf16 v[40:43], a[36:39], v[32:35], v[40:43]
    ds_read_b64_tr_b16 a[6:7], v93 offset:20480
    ds_read_b64_tr_b16 a[8:9], v94 offset:16384
    v_mfma_f32_16x16x32_bf16 v[44:47], a[36:39], v[36:39], v[44:47]
    ds_read_b64_tr_b16 a[10:11], v94 offset:20480
    v_mfma_f32_16x16x32_bf16 v[56:59], a[40:43], v[32:35], v[56:59]
    ds_read_b64_tr_b16 a[12:13], v95 offset:16384
    ds_read_b64_tr_b16 a[14:15], v95 offset:20480
    v_mfma_f32_16x16x32_bf16 v[60:63], a[40:43], v[36:39], v[60:63]
    ds_read_b64_tr_b16 a[16:17], v92 offset:24576
    v_mfma_f32_16x16x32_bf16 v[72:75], a[44:47], v[32:35], v[72:75]
    ds_read_b64_tr_b16 a[18:19], v92 offset:28672
    ds_read_b64_tr_b16 a[20:21], v93 offset:24576
    v_mfma_f32_16x16x32_bf16 v[76:79], a[44:47], v[36:39], v[76:79]
    ds_read_b64_tr_b16 a[22:23], v93 offset:28672
    v_mfma_f32_16x16x32_bf16 a[96:99], a[48:51], v[32:35], a[96:99]
    ds_read_b64_tr_b16 a[24:25], v94 offset:24576
    ds_read_b64_tr_b16 a[26:27], v94 offset:28672
    v_mfma_f32_16x16x32_bf16 a[100:103], a[48:51], v[36:39], a[100:103]
    ds_read_b64_tr_b16 a[28:29], v95 offset:24576
    v_mfma_f32_16x16x32_bf16 a[104:107], a[52:55], v[32:35], a[104:107]
    ds_read_b64_tr_b16 a[30:31], v95 offset:28672
    v_mfma_f32_16x16x32_bf16 a[108:111], a[52:55], v[36:39], a[108:111]
    v_mfma_f32_16x16x32_bf16 a[112:115], a[56:59], v[32:35], a[112:115]
    v_mfma_f32_16x16x32_bf16 a[116:119], a[56:59], v[36:39], a[116:119]
    v_mfma_f32_16x16x32_bf16 a[120:123], a[60:63], v[32:35], a[120:123]
    v_mfma_f32_16x16x32_bf16 a[124:127], a[60:63], v[36:39], a[124:127]
    s_waitcnt vmcnt(8) lgkmcnt(0)
    s_barrier
    v_mfma_f32_16x16x32_bf16 a[96:99], a[0:3], v[48:51], a[96:99]
    ds_read_b64_tr_b16 a[32:33], v92 offset:32768
    ds_read_b64_tr_b16 a[34:35], v92 offset:36864
    v_mfma_f32_16x16x32_bf16 a[100:103], a[0:3], v[52:55], a[100:103]
    ds_read_b64_tr_b16 a[36:37], v93 offset:32768
    v_mfma_f32_16x16x32_bf16 a[104:107], a[4:7], v[48:51], a[104:107]
    ds_read_b64_tr_b16 a[38:39], v93 offset:36864
    ds_read_b64_tr_b16 a[40:41], v94 offset:32768
    v_mfma_f32_16x16x32_bf16 a[108:111], a[4:7], v[52:55], a[108:111]
    ds_read_b64_tr_b16 a[42:43], v94 offset:36864
    v_mfma_f32_16x16x32_bf16 a[112:115], a[8:11], v[48:51], a[112:115]
    ds_read_b64_tr_b16 a[44:45], v95 offset:32768
    ds_read_b64_tr_b16 a[46:47], v95 offset:36864
    v_mfma_f32_16x16x32_bf16 a[116:119], a[8:11], v[52:55], a[116:119]
    ds_read_b64_tr_b16 a[48:49], v92 offset:40960
    v_mfma_f32_16x16x32_bf16 a[120:123], a[12:15], v[48:51], a[120:123]
    ds_read_b64_tr_b16 a[50:51], v92 offset:45056
    ds_read_b64_tr_b16 a[52:53], v93 offset:40960
    v_mfma_f32_16x16x32_bf16 a[124:127], a[12:15], v[52:55], a[124:127]
    ds_read_b64_tr_b16 a[54:55], v93 offset:45056
    v_mfma_f32_16x16x32_bf16 a[96:99], a[16:19], v[64:67], a[96:99]
    ds_read_b64_tr_b16 a[56:57], v94 offset:40960
    ds_read_b64_tr_b16 a[58:59], v94 offset:45056
    v_mfma_f32_16x16x32_bf16 a[100:103], a[16:19], v[68:71], a[100:103]
    ds_read_b64_tr_b16 a[60:61], v95 offset:40960
    v_mfma_f32_16x16x32_bf16 a[104:107], a[20:23], v[64:67], a[104:107]
    ds_read_b64_tr_b16 a[62:63], v95 offset:45056
    v_mfma_f32_16x16x32_bf16 a[108:111], a[20:23], v[68:71], a[108:111]
    v_mfma_f32_16x16x32_bf16 a[112:115], a[24:27], v[64:67], a[112:115]
    v_mfma_f32_16x16x32_bf16 a[116:119], a[24:27], v[68:71], a[116:119]
    v_mfma_f32_16x16x32_bf16 a[120:123], a[28:31], v[64:67], a[120:123]
    v_mfma_f32_16x16x32_bf16 a[124:127], a[28:31], v[68:71], a[124:127]
    s_waitcnt vmcnt(4) lgkmcnt(0)
    s_barrier
    v_mfma_f32_16x16x32_bf16 a[96:99], a[32:35], a[64:67], a[96:99]
    ds_read_b64_tr_b16 a[0:1], v92 offset:49152
    ds_read_b64_tr_b16 a[2:3], v92 offset:53248
    v_mfma_f32_16x16x32_bf16 a[100:103], a[32:35], a[68:71], a[100:103]
    ds_read_b64_tr_b16 a[4:5], v93 offset:49152
    v_mfma_f32_16x16x32_bf16 a[104:107], a[36:39], a[64:67], a[104:107]
    ds_read_b64_tr_b16 a[6:7], v93 offset:53248
    ds_read_b64_tr_b16 a[8:9], v94 offset:49152
    v_mfma_f32_16x16x32_bf16 a[108:111], a[36:39], a[68:71], a[108:111]
    ds_read_b64_tr_b16 a[10:11], v94 offset:53248
    v_mfma_f32_16x16x32_bf16 a[112:115], a[40:43], a[64:67], a[112:115]
    ds_read_b64_tr_b16 a[12:13], v95 offset:49152
    ds_read_b64_tr_b16 a[14:15], v95 offset:53248
    v_mfma_f32_16x16x32_bf16 a[116:119], a[40:43], a[68:71], a[116:119]
    ds_read_b64_tr_b16 a[16:17], v92 offset:57344
    v_mfma_f32_16x16x32_bf16 a[120:123], a[44:47], a[64:67], a[120:123]
    ds_read_b64_tr_b16 a[18:19], v92 offset:61440
    ds_read_b64_tr_b16 a[20:21], v93 offset:57344
    v_mfma_f32_16x16x32_bf16 a[124:127], a[44:47], a[68:71], a[124:127]
    ds_read_b64_tr_b16 a[22:23], v93 offset:61440
    v_mfma_f32_16x16x32_bf16 a[96:99], a[48:51], a[72:75], a[96:99]
    ds_read_b64_tr_b16 a[24:25], v94 offset:57344
    ds_read_b64_tr_b16 a[26:27], v94 offset:61440
    v_mfma_f32_16x16x32_bf16 a[100:103], a[48:51], a[76:79], a[100:103]
    ds_read_b64_tr_b16 a[28:29], v95 offset:57344
    v_mfma_f32_16x16x32_bf16 a[104:107], a[52:55], a[72:75], a[104:107]
    ds_read_b64_tr_b16 a[30:31], v95 offset:61440
    v_mfma_f32_16x16x32_bf16 a[108:111], a[52:55], a[76:79], a[108:111]
    v_mfma_f32_16x16x32_bf16 a[112:115], a[56:59], a[72:75], a[112:115]
    v_mfma_f32_16x16x32_bf16 a[116:119], a[56:59], a[76:79], a[116:119]
    v_mfma_f32_16x16x32_bf16 a[120:123], a[60:63], a[72:75], a[120:123]
    v_mfma_f32_16x16x32_bf16 a[124:127], a[60:63], a[76:79], a[124:127]
    s_waitcnt vmcnt(0) lgkmcnt(0)
    v_mfma_f32_16x16x32_bf16 a[96:99], a[0:3], a[80:83], a[96:99]
    ds_read_b64_tr_b16 a[32:33], v88 offset:16384
    ds_read_b64_tr_b16 a[34:35], v88 offset:20480
    v_mfma_f32_16x16x32_bf16 a[100:103], a[0:3], a[84:87], a[100:103]
    ds_read_b64_tr_b16 a[36:37], v89 offset:16384
    v_mfma_f32_16x16x32_bf16 a[104:107], a[4:7], a[80:83], a[104:107]
    ds_read_b64_tr_b16 a[38:39], v89 offset:20480
    ds_read_b64_tr_b16 a[40:41], v90 offset:16384
    v_mfma_f32_16x16x32_bf16 a[108:111], a[4:7], a[84:87], a[108:111]
    ds_read_b64_tr_b16 a[42:43], v90 offset:20480
    v_mfma_f32_16x16x32_bf16 a[112:115], a[8:11], a[80:83], a[112:115]
    ds_read_b64_tr_b16 a[44:45], v91 offset:16384
    ds_read_b64_tr_b16 a[46:47], v91 offset:20480
    v_mfma_f32_16x16x32_bf16 a[116:119], a[8:11], a[84:87], a[116:119]
    ds_read_b64_tr_b16 a[48:49], v88 offset:24576
    v_mfma_f32_16x16x32_bf16 a[120:123], a[12:15], a[80:83], a[120:123]
    ds_read_b64_tr_b16 a[50:51], v88 offset:28672
    ds_read_b64_tr_b16 a[52:53], v89 offset:24576
    v_mfma_f32_16x16x32_bf16 a[124:127], a[12:15], a[84:87], a[124:127]
    ds_read_b64_tr_b16 a[54:55], v89 offset:28672
    v_mfma_f32_16x16x32_bf16 a[96:99], a[16:19], a[88:91], a[96:99]
    ds_read_b64_tr_b16 a[56:57], v90 offset:24576
    ds_read_b64_tr_b16 a[58:59], v90 offset:28672
    v_mfma_f32_16x16x32_bf16 a[100:103], a[16:19], a[92:95], a[100:103]
    ds_read_b64_tr_b16 a[60:61], v91 offset:24576
    v_mfma_f32_16x16x32_bf16 a[104:107], a[20:23], a[88:91], a[104:107]
    ds_read_b64_tr_b16 a[62:63], v91 offset:28672
    v_mfma_f32_16x16x32_bf16 a[108:111], a[20:23], a[92:95], a[108:111]
    v_mfma_f32_16x16x32_bf16 a[112:115], a[24:27], a[88:91], a[112:115]
    v_mfma_f32_16x16x32_bf16 a[116:119], a[24:27], a[92:95], a[116:119]
    v_mfma_f32_16x16x32_bf16 a[120:123], a[28:31], a[88:91], a[120:123]
    v_mfma_f32_16x16x32_bf16 a[124:127], a[28:31], a[92:95], a[124:127]
    s_waitcnt lgkmcnt(0)
    v_mfma_f32_16x16x32_bf16 v[24:27], a[32:35], v[48:51], v[24:27]
    ds_read_b64_tr_b16 a[0:1], v88 offset:32768
    ds_read_b64_tr_b16 a[2:3], v88 offset:36864
    v_mfma_f32_16x16x32_bf16 v[28:31], a[32:35], v[52:55], v[28:31]
    ds_read_b64_tr_b16 a[4:5], v89 offset:32768
    v_accvgpr_read_b32 v80, a96
    v_accvgpr_read_b32 v81, a97
    v_accvgpr_read_b32 v82, a98
    v_accvgpr_read_b32 v83, a99
    v_cvt_pk_bf16_f32 v96, v80, v81
    v_cvt_pk_bf16_f32 v97, v82, v83
    v_mfma_f32_16x16x32_bf16 v[40:43], a[36:39], v[48:51], v[40:43]
    ds_read_b64_tr_b16 a[6:7], v89 offset:36864
    ds_read_b64_tr_b16 a[8:9], v90 offset:32768
    v_accvgpr_read_b32 v84, a104
    v_accvgpr_read_b32 v85, a105
    v_accvgpr_read_b32 v86, a106
    v_accvgpr_read_b32 v87, a107
    v_cvt_pk_bf16_f32 v98, v84, v85
    v_cvt_pk_bf16_f32 v99, v86, v87
    buffer_store_dwordx4 v[96:99], v2, s[48:51], s24 offen offset:0 sc1
    v_mfma_f32_16x16x32_bf16 v[44:47], a[36:39], v[52:55], v[44:47]
    ds_read_b64_tr_b16 a[10:11], v90 offset:36864
    v_accvgpr_read_b32 v80, a112
    v_accvgpr_read_b32 v81, a113
    v_accvgpr_read_b32 v82, a114
    v_accvgpr_read_b32 v83, a115
    v_cvt_pk_bf16_f32 v100, v80, v81
    v_cvt_pk_bf16_f32 v101, v82, v83
    v_mfma_f32_16x16x32_bf16 v[56:59], a[40:43], v[48:51], v[56:59]
    ds_read_b64_tr_b16 a[12:13], v91 offset:32768
    ds_read_b64_tr_b16 a[14:15], v91 offset:36864
    v_accvgpr_read_b32 v84, a120
    v_accvgpr_read_b32 v85, a121
    v_accvgpr_read_b32 v86, a122
    v_accvgpr_read_b32 v87, a123
    v_cvt_pk_bf16_f32 v102, v84, v85
    v_cvt_pk_bf16_f32 v103, v86, v87
    buffer_store_dwordx4 v[100:103], v2, s[48:51], s24 offen offset:1024 sc1
    v_mfma_f32_16x16x32_bf16 v[60:63], a[40:43], v[52:55], v[60:63]
    ds_read_b64_tr_b16 a[16:17], v88 offset:40960
    v_accvgpr_read_b32 v80, a100
    v_accvgpr_read_b32 v81, a101
    v_accvgpr_read_b32 v82, a102
    v_accvgpr_read_b32 v83, a103
    v_cvt_pk_bf16_f32 v104, v80, v81
    v_cvt_pk_bf16_f32 v105, v82, v83
    v_mfma_f32_16x16x32_bf16 v[72:75], a[44:47], v[48:51], v[72:75]
    ds_read_b64_tr_b16 a[18:19], v88 offset:45056
    ds_read_b64_tr_b16 a[20:21], v89 offset:40960
    v_accvgpr_read_b32 v84, a108
    v_accvgpr_read_b32 v85, a109
    v_accvgpr_read_b32 v86, a110
    v_accvgpr_read_b32 v87, a111
    v_cvt_pk_bf16_f32 v106, v84, v85
    v_cvt_pk_bf16_f32 v107, v86, v87
    buffer_store_dwordx4 v[104:107], v2, s[48:51], s24 offen offset:2048 sc1
    v_mfma_f32_16x16x32_bf16 v[76:79], a[44:47], v[52:55], v[76:79]
    ds_read_b64_tr_b16 a[22:23], v89 offset:45056
    v_accvgpr_read_b32 v80, a116
    v_accvgpr_read_b32 v81, a117
    v_accvgpr_read_b32 v82, a118
    v_accvgpr_read_b32 v83, a119
    v_cvt_pk_bf16_f32 v108, v80, v81
    v_cvt_pk_bf16_f32 v109, v82, v83
    v_mfma_f32_16x16x32_bf16 v[24:27], a[48:51], v[64:67], v[24:27]
    ds_read_b64_tr_b16 a[24:25], v90 offset:40960
    ds_read_b64_tr_b16 a[26:27], v90 offset:45056
    v_accvgpr_read_b32 v84, a124
    v_accvgpr_read_b32 v85, a125
    v_accvgpr_read_b32 v86, a126
    v_accvgpr_read_b32 v87, a127
    v_cvt_pk_bf16_f32 v110, v84, v85
    v_cvt_pk_bf16_f32 v111, v86, v87
    buffer_store_dwordx4 v[108:111], v2, s[48:51], s24 offen offset:3072 sc1
    v_mfma_f32_16x16x32_bf16 v[28:31], a[48:51], v[68:71], v[28:31]
    ds_read_b64_tr_b16 a[28:29], v91 offset:40960
    v_mfma_f32_16x16x32_bf16 v[40:43], a[52:55], v[64:67], v[40:43]
    ds_read_b64_tr_b16 a[30:31], v91 offset:45056
    v_mfma_f32_16x16x32_bf16 v[44:47], a[52:55], v[68:71], v[44:47]
    v_mfma_f32_16x16x32_bf16 v[56:59], a[56:59], v[64:67], v[56:59]
    v_mfma_f32_16x16x32_bf16 v[60:63], a[56:59], v[68:71], v[60:63]
    v_mfma_f32_16x16x32_bf16 v[72:75], a[60:63], v[64:67], v[72:75]
    v_mfma_f32_16x16x32_bf16 v[76:79], a[60:63], v[68:71], v[76:79]
    s_waitcnt lgkmcnt(0)
    v_mfma_f32_16x16x32_bf16 v[24:27], a[0:3], a[64:67], v[24:27]
    ds_read_b64_tr_b16 a[32:33], v88 offset:49152
    ds_read_b64_tr_b16 a[34:35], v88 offset:53248
    v_mfma_f32_16x16x32_bf16 v[28:31], a[0:3], a[68:71], v[28:31]
    ds_read_b64_tr_b16 a[36:37], v89 offset:49152
    v_mfma_f32_16x16x32_bf16 v[40:43], a[4:7], a[64:67], v[40:43]
    ds_read_b64_tr_b16 a[38:39], v89 offset:53248
    ds_read_b64_tr_b16 a[40:41], v90 offset:49152
    v_mfma_f32_16x16x32_bf16 v[44:47], a[4:7], a[68:71], v[44:47]
    ds_read_b64_tr_b16 a[42:43], v90 offset:53248
    v_mfma_f32_16x16x32_bf16 v[56:59], a[8:11], a[64:67], v[56:59]
    ds_read_b64_tr_b16 a[44:45], v91 offset:49152
    ds_read_b64_tr_b16 a[46:47], v91 offset:53248
    v_mfma_f32_16x16x32_bf16 v[60:63], a[8:11], a[68:71], v[60:63]
    ds_read_b64_tr_b16 a[48:49], v88 offset:57344
    v_mfma_f32_16x16x32_bf16 v[72:75], a[12:15], a[64:67], v[72:75]
    ds_read_b64_tr_b16 a[50:51], v88 offset:61440
    ds_read_b64_tr_b16 a[52:53], v89 offset:57344
    v_mfma_f32_16x16x32_bf16 v[76:79], a[12:15], a[68:71], v[76:79]
    ds_read_b64_tr_b16 a[54:55], v89 offset:61440
    v_mfma_f32_16x16x32_bf16 v[24:27], a[16:19], a[72:75], v[24:27]
    ds_read_b64_tr_b16 a[56:57], v90 offset:57344
    ds_read_b64_tr_b16 a[58:59], v90 offset:61440
    v_mfma_f32_16x16x32_bf16 v[28:31], a[16:19], a[76:79], v[28:31]
    ds_read_b64_tr_b16 a[60:61], v91 offset:57344
    v_mfma_f32_16x16x32_bf16 v[40:43], a[20:23], a[72:75], v[40:43]
    ds_read_b64_tr_b16 a[62:63], v91 offset:61440
    v_mfma_f32_16x16x32_bf16 v[44:47], a[20:23], a[76:79], v[44:47]
    v_mfma_f32_16x16x32_bf16 v[56:59], a[24:27], a[72:75], v[56:59]
    v_mfma_f32_16x16x32_bf16 v[60:63], a[24:27], a[76:79], v[60:63]
    v_mfma_f32_16x16x32_bf16 v[72:75], a[28:31], a[72:75], v[72:75]
    v_mfma_f32_16x16x32_bf16 v[76:79], a[28:31], a[76:79], v[76:79]
    s_waitcnt lgkmcnt(0)
    v_mfma_f32_16x16x32_bf16 v[24:27], a[32:35], a[80:83], v[24:27]
    v_mfma_f32_16x16x32_bf16 v[28:31], a[32:35], a[84:87], v[28:31]
    v_mfma_f32_16x16x32_bf16 v[40:43], a[36:39], a[80:83], v[40:43]
    v_mfma_f32_16x16x32_bf16 v[44:47], a[36:39], a[84:87], v[44:47]
    v_mfma_f32_16x16x32_bf16 v[56:59], a[40:43], a[80:83], v[56:59]
    v_mfma_f32_16x16x32_bf16 v[60:63], a[40:43], a[84:87], v[60:63]
    v_mfma_f32_16x16x32_bf16 v[72:75], a[44:47], a[80:83], v[72:75]
    v_mfma_f32_16x16x32_bf16 v[76:79], a[44:47], a[84:87], v[76:79]
    v_mfma_f32_16x16x32_bf16 v[24:27], a[48:51], a[88:91], v[24:27]
    v_mfma_f32_16x16x32_bf16 v[28:31], a[48:51], a[92:95], v[28:31]
    v_mfma_f32_16x16x32_bf16 v[40:43], a[52:55], a[88:91], v[40:43]
    v_mfma_f32_16x16x32_bf16 v[44:47], a[52:55], a[92:95], v[44:47]
    v_mfma_f32_16x16x32_bf16 v[56:59], a[56:59], a[88:91], v[56:59]
    v_mfma_f32_16x16x32_bf16 v[60:63], a[56:59], a[92:95], v[60:63]
    v_mfma_f32_16x16x32_bf16 v[72:75], a[60:63], a[88:91], v[72:75]
    v_mfma_f32_16x16x32_bf16 v[76:79], a[60:63], a[92:95], v[76:79]
    s_waitcnt vmcnt(0)
    buffer_store_dwordx2 v[4:5], v7, s[48:51], s18 offen sc1
    s_mov_b32 s39, 0
L_xl:
    s_sleep 0
    buffer_load_dwordx2 v[8:9], v7, s[48:51], s19 offen sc1
    s_add_u32 s39, s39, 1
    s_cmp_gt_u32 s39, 0x80000
    s_cbranch_scc1 L_xd
    s_waitcnt vmcnt(0)
    v_cmp_ne_u64 vcc, v[8:9], v[4:5]
    s_cbranch_vccnz L_xl
    buffer_load_dwordx4 v[96:99], v2, s[48:51], s26 offen offset:0 sc1
    buffer_load_dwordx4 v[100:103], v2, s[48:51], s26 offen offset:1024 sc1
    buffer_load_dwordx4 v[104:107], v2, s[48:51], s26 offen offset:2048 sc1
    buffer_load_dwordx4 v[108:111], v2, s[48:51], s26 offen offset:3072 sc1
L_xc:
L_xd:
    s_waitcnt vmcnt(0)
    v_lshlrev_b32 v80, 16, v96
    v_and_b32 v81, 0xffff0000, v96
    v_lshlrev_b32 v82, 16, v97
    v_and_b32 v83, 0xffff0000, v97
    v_pk_add_f32 v[24:25], v[24:25], v[80:81]
    v_pk_add_f32 v[26:27], v[26:27], v[82:83]
    v_cvt_pk_bf16_f32 v16, v24, v25
    v_cvt_pk_bf16_f32 v17, v26, v27
    v_lshlrev_b32 v84, 16, v98
    v_and_b32 v85, 0xffff0000, v98
    v_lshlrev_b32 v86, 16, v99
    v_and_b32 v87, 0xffff0000, v99
    v_pk_add_f32 v[40:41], v[40:41], v[84:85]
    v_pk_add_f32 v[42:43], v[42:43], v[86:87]
    v_cvt_pk_bf16_f32 v18, v40, v41
    v_cvt_pk_bf16_f32 v19, v42, v43
    s_nop 1
    v_permlane16_swap_b32 v16, v18
    v_permlane16_swap_b32 v17, v19
    v_lshlrev_b32 v80, 16, v100
    v_and_b32 v81, 0xffff0000, v100
    v_lshlrev_b32 v82, 16, v101
    v_and_b32 v83, 0xffff0000, v101
    v_pk_add_f32 v[56:57], v[56:57], v[80:81]
    v_pk_add_f32 v[58:59], v[58:59], v[82:83]
    v_cvt_pk_bf16_f32 v32, v56, v57
    v_cvt_pk_bf16_f32 v33, v58, v59
    v_lshlrev_b32 v84, 16, v102
    v_and_b32 v85, 0xffff0000, v102
    v_lshlrev_b32 v86, 16, v103
    v_and_b32 v87, 0xffff0000, v103
    v_pk_add_f32 v[72:73], v[72:73], v[84:85]
    v_pk_add_f32 v[74:75], v[74:75], v[86:87]
    v_cvt_pk_bf16_f32 v34, v72, v73
    v_cvt_pk_bf16_f32 v35, v74, v75
    s_nop 1
    v_permlane16_swap_b32 v32, v34
    v_permlane16_swap_b32 v33, v35
    v_mov_b32 v20, v16
    v_mov_b32 v21, v17
    v_mov_b32 v22, v18
    v_mov_b32 v23, v19
    v_mov_b32_dpp v16, v32 row_ror:8 row_mask:0xf bank_mask:0xc
    v_mov_b32_dpp v17, v33 row_ror:8 row_mask:0xf bank_mask:0xc
    v_mov_b32_dpp v18, v34 row_ror:8 row_mask:0xf bank_mask:0xc
    v_mov_b32_dpp v19, v35 row_ror:8 row_mask:0xf bank_mask:0xc
    buffer_store_dwordx4 v[16:19], v12, s[32:35], 0 offen sc1
    v_mov_b32_dpp v32, v20 row_ror:8 row_mask:0xf bank_mask:0x3
    v_mov_b32_dpp v33, v21 row_ror:8 row_mask:0xf bank_mask:0x3
    v_mov_b32_dpp v34, v22 row_ror:8 row_mask:0xf bank_mask:0x3
    v_mov_b32_dpp v35, v23 row_ror:8 row_mask:0xf bank_mask:0x3
    buffer_store_dwordx4 v[32:35], v12, s[32:35], s21 offen sc1
    v_lshlrev_b32 v80, 16, v104
    v_and_b32 v81, 0xffff0000, v104
    v_lshlrev_b32 v82, 16, v105
    v_and_b32 v83, 0xffff0000, v105
    v_pk_add_f32 v[28:29], v[28:29], v[80:81]
    v_pk_add_f32 v[30:31], v[30:31], v[82:83]
    v_cvt_pk_bf16_f32 v48, v28, v29
    v_cvt_pk_bf16_f32 v49, v30, v31
    v_lshlrev_b32 v84, 16, v106
    v_and_b32 v85, 0xffff0000, v106
    v_lshlrev_b32 v86, 16, v107
    v_and_b32 v87, 0xffff0000, v107
    v_pk_add_f32 v[44:45], v[44:45], v[84:85]
    v_pk_add_f32 v[46:47], v[46:47], v[86:87]
    v_cvt_pk_bf16_f32 v50, v44, v45
    v_cvt_pk_bf16_f32 v51, v46, v47
    s_nop 1
    v_permlane16_swap_b32 v48, v50
    v_permlane16_swap_b32 v49, v51
    v_lshlrev_b32 v80, 16, v108
    v_and_b32 v81, 0xffff0000, v108
    v_lshlrev_b32 v82, 16, v109
    v_and_b32 v83, 0xffff0000, v109
    v_pk_add_f32 v[60:61], v[60:61], v[80:81]
    v_pk_add_f32 v[62:63], v[62:63], v[82:83]
    v_cvt_pk_bf16_f32 v64, v60, v61
    v_cvt_pk_bf16_f32 v65, v62, v63
    v_lshlrev_b32 v84, 16, v110
    v_and_b32 v85, 0xffff0000, v110
    v_lshlrev_b32 v86, 16, v111
    v_and_b32 v87, 0xffff0000, v111
    v_pk_add_f32 v[76:77], v[76:77], v[84:85]
    v_pk_add_f32 v[78:79], v[78:79], v[86:87]
    v_cvt_pk_bf16_f32 v66, v76, v77
    v_cvt_pk_bf16_f32 v67, v78, v79
    s_nop 1
    v_permlane16_swap_b32 v64, v66
    v_permlane16_swap_b32 v65, v67
    v_mov_b32 v52, v48
    v_mov_b32 v53, v49
    v_mov_b32 v54, v50
    v_mov_b32 v55, v51
    v_mov_b32_dpp v48, v64 row_ror:8 row_mask:0xf bank_mask:0xc
    v_mov_b32_dpp v49, v65 row_ror:8 row_mask:0xf bank_mask:0xc
    v_mov_b32_dpp v50, v66 row_ror:8 row_mask:0xf bank_mask:0xc
    v_mov_b32_dpp v51, v67 row_ror:8 row_mask:0xf bank_mask:0xc
    buffer_store_dwordx4 v[48:51], v13, s[32:35], 0 offen sc1
    v_mov_b32_dpp v64, v52 row_ror:8 row_mask:0xf bank_mask:0x3
    v_mov_b32_dpp v65, v53 row_ror:8 row_mask:0xf bank_mask:0x3
    v_mov_b32_dpp v66, v54 row_ror:8 row_mask:0xf bank_mask:0x3
    v_mov_b32_dpp v67, v55 row_ror:8 row_mask:0xf bank_mask:0x3
    buffer_store_dwordx4 v[64:67], v13, s[32:35], s21 offen sc1
L1_end:
    s_endpgm
.section .rodata,"a"
.p2align 6
.amdhsa_kernel standalone__dense_activation_squared_relu__prompt_kernel
  .amdhsa_next_free_vgpr 256
  .amdhsa_next_free_sgpr 102
  .amdhsa_accum_offset 128
  .amdhsa_group_segment_fixed_size 0
  .amdhsa_kernarg_size 64
  .amdhsa_user_sgpr_count 2
  .amdhsa_user_sgpr_kernarg_segment_ptr 1
  .amdhsa_system_sgpr_workgroup_id_x 1
.end_amdhsa_kernel
```
